```python
import torch

def _softmax(x, axis=-1):
    return torch.softmax(x, dim=axis)
def _gelu(x):
    return torch.nn.functional.gelu(x, approximate="tanh")
def _silu(x):
    return torch.nn.functional.silu(x)
def _sigmoid(x):
    return torch.sigmoid(x)
def _layernorm(x, axis=-1, eps=1e-5):
    m = x.mean(dim=axis, keepdim=True)
    v = x.var(dim=axis, keepdim=True, unbiased=False)
    return (x - m) / torch.sqrt(v + eps)
def _scatter_add(tgt, idx, src, axis=0):
    return tgt.clone().index_add_(axis, idx, src)
def _segment_sum(src, seg, n):
    out = torch.zeros((n,) + src.shape[1:], dtype=src.dtype)
    return out.index_add_(0, seg, src)
def _pad(x, pw):
    flat = tuple(v for pair in reversed(pw) for v in pair)
    return torch.nn.functional.pad(x, flat)

kernel_name = 'recurrent_scan__ssm_conv_s4__dense_activation_gelu__prompt'

def setup_inputs():

    _w = (lambda a: (lambda t: t.to(torch.bfloat16) if t.is_floating_point() else t)(torch.as_tensor(a)))
    def _A_setup():
        B, L, D, N = 1, 2048, 640, 128
        A_re = -(lambda _x: torch.exp(torch.as_tensor(_x)))((lambda *s: torch.randn(*s, dtype=torch.bfloat16) * 6.4)(D, N))
        A_im = torch.pi * (lambda *s: torch.randn(*s, dtype=torch.bfloat16) * 0.2)(D, N)
        B_re = (lambda *s: torch.randn(*s, dtype=torch.bfloat16) * 0.2)(D, N)
        B_im = (lambda *s: torch.randn(*s, dtype=torch.bfloat16) * 0.2)(D, N)
        C_re = (lambda *s: torch.randn(*s, dtype=torch.bfloat16) * 0.2)(D, N)
        C_im = (lambda *s: torch.randn(*s, dtype=torch.bfloat16) * 0.2)(D, N)
        log_dt = (lambda *s: torch.randn(*s, dtype=torch.bfloat16) * 0.2)(D) * 0.5 - 4.0
        Dskip = (lambda *s: torch.randn(*s, dtype=torch.bfloat16) * 0.2)(D)
        return {
            "u": _w((lambda *s: torch.randn(*s, dtype=torch.bfloat16) * 0.05)(B, L, D)),
            "A_re": _w(A_re),
            "A_im": _w(A_im),
            "B_re": _w(B_re),
            "B_im": _w(B_im),
            "C_re": _w(C_re),
            "C_im": _w(C_im),
            "log_dt": _w(log_dt),
            "Dskip": _w(Dskip),
        }
    _A_in = _A_setup()

    def _B_setup():
        B, S, D, F = 1, 2048, 640, 1728
        return {
            "x": _w((lambda *s: torch.randn(*s, dtype=torch.bfloat16) * 0.05)(B, S, D)),
            "w1": _w((lambda *s: torch.randn(*s, dtype=torch.bfloat16) * 0.8)(D, F) * (D ** -0.5)),
            "b1": _w((lambda *s: torch.randn(*s, dtype=torch.bfloat16) * 0.1)(F) * 0.01),
            "w2": _w((lambda *s: torch.randn(*s, dtype=torch.bfloat16) * 0.1)(F, D) * (F ** -0.5)),
            "b2": _w((lambda *s: torch.randn(*s, dtype=torch.bfloat16) * 0.1)(D) * 0.01),
        }
    _B_in = _B_setup()

    return {
        "A_u": _A_in["u"],
        "A_A_re": _A_in["A_re"],
        "A_A_im": _A_in["A_im"],
        "A_B_re": _A_in["B_re"],
        "A_B_im": _A_in["B_im"],
        "A_C_re": _A_in["C_re"],
        "A_C_im": _A_in["C_im"],
        "A_log_dt": _A_in["log_dt"],
        "A_Dskip": _A_in["Dskip"],
        "B_x": _B_in["x"],
        "B_w1": _B_in["w1"],
        "B_b1": _B_in["b1"],
        "B_w2": _B_in["w2"],
        "B_b2": _B_in["b2"],
    }

def reference(A_u, A_A_re, A_A_im, A_B_re, A_B_im, A_C_re, A_C_im, A_log_dt, A_Dskip, B_x, B_w1, B_b1, B_w2, B_b2):
    def _A_ref(u, A_re, A_im, B_re, B_im, C_re, C_im, log_dt, Dskip):
        Bsz, L, D = u.shape
        dt = torch.exp(log_dt)[:, None]
        A = A_re + 1j * A_im
        Bc = B_re + 1j * B_im
        Cc = C_re + 1j * C_im
        logdA = dt * A
        dB = dt * Bc
        l = (lambda x, dt: x.to(dt))(torch.arange(L), A_re.dtype)
        P = torch.exp(logdA[:, :, None] * l[None, None, :])
        K = torch.einsum("dn,dnl,dn->dl", Cc, P, dB).real
        L2 = 2 * L
        Kp = _pad(K, ((0, 0), (0, L)))
        up = (lambda x, *d: x.permute(*d))(u, 0, 2, 1)
        up = _pad(up, ((0, 0), (0, 0), (0, L)))
        Kf = (lambda x, axes=(-2,-1): torch.fft.rfft2(x.float(), dim=axes))(Kp[:, None, :], axes=(-2, -1))
        Uf = (lambda x, axes=(-2,-1): torch.fft.rfft2(x.float(), dim=axes))(up[:, :, None, :], axes=(-2, -1))
        Yf = Uf * Kf[None, :, :, :]
        y = (lambda x, s, axes=(-2,-1): torch.fft.irfft2(x, s=s, dim=axes).to(torch.bfloat16))(Yf, (1, L2), axes=(-2, -1))[:, :, 0, :L]
        y = (lambda x, *d: x.permute(*d))(y, 0, 2, 1) + u * Dskip[None, None, :]
        return y

    def _B_ref(x, w1, b1, w2, b2):
        h = torch.einsum("bsd,df->bsf", x, w1) + b1
        h = _gelu(h)
        return torch.einsum("bsf,fd->bsd", h, w2) + b2

    x = A_u
    xn = _layernorm(x, axis=-1)
    s = _A_ref(xn, A_A_re, A_A_im, A_B_re, A_B_im, A_C_re, A_C_im, A_log_dt, A_Dskip)
    g = _silu(_B_ref(xn, B_w1, B_b1, B_w2, B_b2))
    return x + s * g
```

```asm
; @launch grid=(256,1,1) block=(512,1,1) lds=163840
.amdgcn_target "amdgcn-amd-amdhsa--gfx950"
.text
.globl recurrent_scan__ssm_conv_s4__dense_activation_gelu__prompt_kernel
.p2align 8
.type recurrent_scan__ssm_conv_s4__dense_activation_gelu__prompt_kernel,@function
recurrent_scan__ssm_conv_s4__dense_activation_gelu__prompt_kernel:
    s_cmp_ge_u32 s2, 256
    s_cbranch_scc1 L_exit
    s_load_dwordx16 s[4:19], s[0:1], 0
    s_load_dwordx16 s[20:35], s[0:1], 64
    s_load_dwordx2 s[36:37], s[0:1], 128
    v_and_b32 v1, 63, v0
    v_lshrrev_b32 v2, 6, v0
    v_lshlrev_b32 v3, 2, v1
    v_readfirstlane_b32 s3, v2
    v_add_u32 v3, 0, v3
    v_mov_b32 v2, 0
    ds_write_b32 v3, v2
    s_and_b32 s38, s2, 7
    s_lshr_b32 s39, s2, 3
    s_lshl_b32 s62, s3, 5
    s_add_u32 s62, s62, s39
    s_cmp_ge_u32 s62, (L_code_end - L_code_pc + 1023) / 1024
    s_cbranch_scc1 L_nocpf
    s_getpc_b64 s[64:65]
L_code_pc:
    s_and_b32 s64, s64, -128
    s_lshl_b32 s62, s62, 10
    v_lshl_add_u32 v250, v1, 4, s62
    v_min_u32 v250, L_code_end - L_code_pc - 16, v250
    global_load_dwordx4 v[252:255], v250, s[64:65]
L_nocpf:
    s_max_u32 s61, s39, 4
    s_sub_u32 s61, s61, 4
    s_lshr_b32 s62, s38, 1
    s_and_b32 s63, s38, 1
    s_and_b32 s60, s61, 3
    s_lshr_b32 s61, s61, 2
    s_lshl_b32 s64, s62, 2
    s_add_u32 s60, s60, s64
    s_mul_i32 s64, s63, 7
    s_add_u32 s61, s61, s64
    s_lshl_b32 s56, s62, 3
    s_lshr_b32 s64, s39, 2
    s_add_u32 s56, s56, s64
    s_lshl_b32 s57, s63, 2
    s_and_b32 s64, s39, 3
    s_add_u32 s57, s57, s64
    s_lshr_b32 s58, s2, 1
    s_mul_i32 s58, s58, 5
    v_lshrrev_b32 v10, 3, v1
    v_lshrrev_b32 v11, 4, v1
    v_and_b32 v12, 7, v1
    v_xor_b32 v12, v12, v11
    v_mul_u32_u24 v10, 1280, v10
    v_lshl_add_u32 v4, v12, 4, v10
    v_xor_b32 v12, 4, v12
    v_lshl_add_u32 v5, v12, 4, v10
    v_add_u32 v6, 18432, v4
    v_add_u32 v7, 27648, v5
    v_add_u32 v5, 9216, v5
    v_and_b32 v12, 15, v1
    v_lshlrev_b32 v13, 1, v11
    v_xor_b32 v12, v12, v13
    v_mul_u32_u24 v10, 3456, v11
    v_lshl_add_u32 v14, v12, 4, v10
    v_xor_b32 v12, 8, v12
    v_lshl_add_u32 v16, v12, 4, v10
    v_add_u32 v15, 12800, v14
    v_add_u32 v17, 38400, v16
    v_add_u32 v16, 25600, v16
    v_and_b32 v148, 15, v1
    v_lshlrev_b32 v148, 1, v148
    v_lshl_add_u32 v148, v11, 20, v148
    s_lshl_b32 s69, s61, 8
    s_and_b32 s62, s3, 1
    s_lshl_b32 s62, s62, 7
    s_add_u32 s69, s69, s62
    s_lshr_b32 s62, s3, 1
    s_lshl_b32 s62, s62, 6
    s_add_u32 s69, s69, s62
    s_xor_b32 s68, s69, 64
    s_mov_b32 s54, 3456
    s_mov_b32 s55, 0x20000
    s_max_u32 s62, s3, 5
    s_sub_u32 s62, s62, 5
    s_and_b32 s64, s2, 1
    s_mul_i32 s64, s64, 3
    s_cmp_eq_u32 s62, 2
    s_cselect_b32 s64, 0, s64
    s_add_u32 s76, s58, s64
    s_add_u32 s76, s76, s62
    s_lshl_b32 s64, s76, 8
    v_lshl_add_u32 v3, v1, 2, s64
    s_lshl_b32 s64, s76, 1
    s_and_b32 s64, s64, -4
    s_cmp_ge_u32 s3, 4
    s_waitcnt lgkmcnt(0)
    s_cbranch_scc0 L_b1
    s_cmp_eq_u32 s3, 4
    s_cbranch_scc1 L_nob1
    global_load_dword v4, v3, s[6:7] nt
    global_load_dword v5, v3, s[8:9] nt
    global_load_dword v6, v3, s[10:11] nt
    global_load_dword v7, v3, s[12:13] nt
    global_load_dword v8, v3, s[14:15] nt
    global_load_dword v9, v3, s[16:17] nt
    s_load_dword s65, s[18:19], s64
    s_load_dword s66, s[20:21], s64
    v_lshlrev_b32 v245, 4, v1
    global_load_dword v237, v245, s[30:31] offset:256
    global_load_dword v237, v245, s[30:31]
    s_branch L_nob1
L_b1:
    s_mov_b32 s52, s26
    s_and_b32 s53, s27, 0xffff
    buffer_load_ushort v161, v148, s[52:55], s69 offen offset:0
    buffer_load_ushort v163, v148, s[52:55], s69 offen offset:32
    buffer_load_ushort v165, v148, s[52:55], s68 offen offset:0
    buffer_load_ushort v167, v148, s[52:55], s68 offen offset:32
L_nob1:
    s_cmp_ge_u32 s39, 4
    s_cbranch_scc1 L_nobar
    s_barrier
L_nobar:
    s_mov_b32 s40, s36
    s_and_b32 s41, s37, 0xffff
    s_mov_b32 s42, 20971520
    s_mov_b32 s43, 0x20000
    s_cmp_gt_u32 s3, 4
    s_cbranch_scc1 L_kwave
    s_cmp_lt_u32 s39, 4
    s_cbranch_scc1 L_helper
    s_cmp_lt_u32 s3, 4
    s_cbranch_scc1 L_gwave
    s_setprio 3
    s_mov_b32 s44, s4
    s_and_b32 s45, s5, 0xffff
    s_mov_b32 s46, 2621440
    s_mov_b32 s47, 0x20000
    s_mov_b32 s48, s24
    s_and_b32 s49, s25, 0xffff
    s_mov_b32 s50, 2211840
    s_mov_b32 s51, 0x20000
    s_mul_i32 s62, s60, 163840
    s_lshl_b32 s63, s61, 8
    s_lshr_b32 s64, s38, 1
    s_mul_i32 s64, s64, 5
    s_add_u32 s64, s64, 1
    s_lshr_b32 s64, s64, 1
    s_and_b32 s65, s38, 1
    s_mul_i32 s65, s65, 0
    s_add_u32 s64, s64, s65
    s_mul_i32 s65, s64, 205
    s_lshr_b32 s65, s65, 11
    s_mul_i32 s65, s65, 10
    s_sub_u32 s66, s64, s65
    s_lshl_b32 s64, s66, 7
    s_add_u32 s62, s62, s64
    s_mul_i32 s64, s66, 221184
    s_add_u32 s63, s63, s64
    s_add_u32 s69, s62, 0
    s_mov_b32 m0, 256
    s_nop 0
    buffer_load_dwordx4 v4, s[44:47], s69 offen offset:0 lds
    buffer_load_dwordx4 v5, s[44:47], s69 offen offset:1024 lds
    buffer_load_dwordx4 v6, s[44:47], s69 offen offset:2048 lds
    buffer_load_dwordx4 v7, s[44:47], s69 offen offset:3072 lds
    s_add_u32 s70, s63, 0
    s_mov_b32 m0, 16640
    s_nop 0
    buffer_load_dwordx4 v14, s[48:51], s70 offen offset:0 lds
    buffer_load_dwordx4 v15, s[48:51], s70 offen offset:1024 lds
    buffer_load_dwordx4 v16, s[48:51], s70 offen offset:2048 lds
    buffer_load_dwordx4 v17, s[48:51], s70 offen offset:3072 lds
    s_add_u32 s69, s62, 40960
    s_mov_b32 m0, 4352
    s_nop 0
    buffer_load_dwordx4 v4, s[44:47], s69 offen offset:0 lds
    buffer_load_dwordx4 v5, s[44:47], s69 offen offset:1024 lds
    buffer_load_dwordx4 v6, s[44:47], s69 offen offset:2048 lds
    buffer_load_dwordx4 v7, s[44:47], s69 offen offset:3072 lds
    s_add_u32 s70, s63, 55296
    s_mov_b32 m0, 20736
    s_nop 0
    buffer_load_dwordx4 v14, s[48:51], s70 offen offset:0 lds
    buffer_load_dwordx4 v15, s[48:51], s70 offen offset:1024 lds
    buffer_load_dwordx4 v16, s[48:51], s70 offen offset:2048 lds
    buffer_load_dwordx4 v17, s[48:51], s70 offen offset:3072 lds
    s_add_u32 s69, s62, 81920
    s_mov_b32 m0, 8448
    s_nop 0
    buffer_load_dwordx4 v4, s[44:47], s69 offen offset:0 lds
    buffer_load_dwordx4 v5, s[44:47], s69 offen offset:1024 lds
    buffer_load_dwordx4 v6, s[44:47], s69 offen offset:2048 lds
    buffer_load_dwordx4 v7, s[44:47], s69 offen offset:3072 lds
    s_add_u32 s70, s63, 110592
    s_mov_b32 m0, 24832
    s_nop 0
    buffer_load_dwordx4 v14, s[48:51], s70 offen offset:0 lds
    buffer_load_dwordx4 v15, s[48:51], s70 offen offset:1024 lds
    buffer_load_dwordx4 v16, s[48:51], s70 offen offset:2048 lds
    buffer_load_dwordx4 v17, s[48:51], s70 offen offset:3072 lds
    s_add_u32 s69, s62, 122880
    s_mov_b32 m0, 12544
    s_nop 0
    buffer_load_dwordx4 v4, s[44:47], s69 offen offset:0 lds
    buffer_load_dwordx4 v5, s[44:47], s69 offen offset:1024 lds
    buffer_load_dwordx4 v6, s[44:47], s69 offen offset:2048 lds
    buffer_load_dwordx4 v7, s[44:47], s69 offen offset:3072 lds
    s_add_u32 s70, s63, 165888
    s_mov_b32 m0, 28928
    s_nop 0
    buffer_load_dwordx4 v14, s[48:51], s70 offen offset:0 lds
    buffer_load_dwordx4 v15, s[48:51], s70 offen offset:1024 lds
    buffer_load_dwordx4 v16, s[48:51], s70 offen offset:2048 lds
    buffer_load_dwordx4 v17, s[48:51], s70 offen offset:3072 lds
    s_cmp_eq_u32 s66, 9
    s_cselect_b32 s64, 1280, 0
    s_cselect_b32 s65, 2211840, 0
    s_sub_u32 s62, s62, s64
    s_sub_u32 s63, s63, s65
    s_add_u32 s69, s62, 128
    s_mov_b32 m0, 33024
    s_nop 0
    buffer_load_dwordx4 v4, s[44:47], s69 offen offset:0 lds
    buffer_load_dwordx4 v5, s[44:47], s69 offen offset:1024 lds
    buffer_load_dwordx4 v6, s[44:47], s69 offen offset:2048 lds
    buffer_load_dwordx4 v7, s[44:47], s69 offen offset:3072 lds
    s_add_u32 s70, s63, 221184
    s_mov_b32 m0, 49408
    s_nop 0
    buffer_load_dwordx4 v14, s[48:51], s70 offen offset:0 lds
    buffer_load_dwordx4 v15, s[48:51], s70 offen offset:1024 lds
    buffer_load_dwordx4 v16, s[48:51], s70 offen offset:2048 lds
    buffer_load_dwordx4 v17, s[48:51], s70 offen offset:3072 lds
    s_mov_b32 s52, s34
    s_and_b32 s53, s35, 0xffff
    s_mov_b32 s54, 256
    s_mov_b32 s55, 0x20000
    v_lshlrev_b32 v30, 4, v1
    v_lshlrev_b32 v32, 2, v1
    s_lshr_b32 s72, s58, 7
    s_add_u32 s73, s58, 4
    s_lshr_b32 s73, s73, 7
    s_sub_u32 s73, s73, s72
    s_cmp_eq_u32 s73, 0
    s_cselect_b32 s73, 0x7f, -1
    v_and_b32 v33, s73, v32
    v_lshlrev_b32 v33, 5, v33
    s_lshl_b32 s72, s72, 12
    s_add_u32 s72, s72, 15106048
    v_mov_b32 v35, 0
    v_lshrrev_b32 v24, 2, v1
    v_mul_u32_u24 v24, 1280, v24
    v_and_b32 v25, 3, v1
    v_lshl_add_u32 v24, v25, 4, v24
    v_and_b32 v20, 3, v1
    v_lshlrev_b32 v20, 2, v20
    v_add_u32 v20, 16, v20
    s_add_u32 s69, s62, 41088
    s_mov_b32 m0, 37120
    s_nop 0
    buffer_load_dwordx4 v4, s[44:47], s69 offen offset:0 lds
    buffer_load_dwordx4 v5, s[44:47], s69 offen offset:1024 lds
    buffer_load_dwordx4 v6, s[44:47], s69 offen offset:2048 lds
    buffer_load_dwordx4 v7, s[44:47], s69 offen offset:3072 lds
    s_add_u32 s70, s63, 276480
    s_mov_b32 m0, 53504
    s_nop 0
    buffer_load_dwordx4 v14, s[48:51], s70 offen offset:0 lds
    buffer_load_dwordx4 v15, s[48:51], s70 offen offset:1024 lds
    buffer_load_dwordx4 v16, s[48:51], s70 offen offset:2048 lds
    buffer_load_dwordx4 v17, s[48:51], s70 offen offset:3072 lds
    s_add_u32 s69, s62, 82048
    s_mov_b32 m0, 41216
    s_nop 0
    buffer_load_dwordx4 v4, s[44:47], s69 offen offset:0 lds
    buffer_load_dwordx4 v5, s[44:47], s69 offen offset:1024 lds
    buffer_load_dwordx4 v6, s[44:47], s69 offen offset:2048 lds
    buffer_load_dwordx4 v7, s[44:47], s69 offen offset:3072 lds
    s_add_u32 s70, s63, 331776
    s_mov_b32 m0, 57600
    s_nop 0
    buffer_load_dwordx4 v14, s[48:51], s70 offen offset:0 lds
    buffer_load_dwordx4 v15, s[48:51], s70 offen offset:1024 lds
    buffer_load_dwordx4 v16, s[48:51], s70 offen offset:2048 lds
    buffer_load_dwordx4 v17, s[48:51], s70 offen offset:3072 lds
    s_add_u32 s69, s62, 123008
    s_mov_b32 m0, 45312
    s_nop 0
    buffer_load_dwordx4 v4, s[44:47], s69 offen offset:0 lds
    buffer_load_dwordx4 v5, s[44:47], s69 offen offset:1024 lds
    buffer_load_dwordx4 v6, s[44:47], s69 offen offset:2048 lds
    buffer_load_dwordx4 v7, s[44:47], s69 offen offset:3072 lds
    s_add_u32 s70, s63, 387072
    s_mov_b32 m0, 61696
    s_nop 0
    buffer_load_dwordx4 v14, s[48:51], s70 offen offset:0 lds
    buffer_load_dwordx4 v15, s[48:51], s70 offen offset:1024 lds
    buffer_load_dwordx4 v16, s[48:51], s70 offen offset:2048 lds
    buffer_load_dwordx4 v17, s[48:51], s70 offen offset:3072 lds
    s_waitcnt vmcnt(32)
    s_barrier
    s_cmp_eq_u32 s66, 8
    s_cselect_b32 s64, 1280, 0
    s_cselect_b32 s65, 2211840, 0
    s_sub_u32 s62, s62, s64
    s_sub_u32 s63, s63, s65
    s_add_u32 s69, s62, 256
    s_mov_b32 m0, 65792
    s_nop 0
    buffer_load_dwordx4 v4, s[44:47], s69 offen offset:0 lds
    buffer_load_dwordx4 v5, s[44:47], s69 offen offset:1024 lds
    buffer_load_dwordx4 v6, s[44:47], s69 offen offset:2048 lds
    buffer_load_dwordx4 v7, s[44:47], s69 offen offset:3072 lds
    s_add_u32 s70, s63, 442368
    s_mov_b32 m0, 82176
    s_nop 0
    buffer_load_dwordx4 v14, s[48:51], s70 offen offset:0 lds
    buffer_load_dwordx4 v15, s[48:51], s70 offen offset:1024 lds
    buffer_load_dwordx4 v16, s[48:51], s70 offen offset:2048 lds
    buffer_load_dwordx4 v17, s[48:51], s70 offen offset:3072 lds
    s_add_u32 s69, s62, 41216
    s_mov_b32 m0, 69888
    s_nop 0
    buffer_load_dwordx4 v4, s[44:47], s69 offen offset:0 lds
    buffer_load_dwordx4 v5, s[44:47], s69 offen offset:1024 lds
    buffer_load_dwordx4 v6, s[44:47], s69 offen offset:2048 lds
    buffer_load_dwordx4 v7, s[44:47], s69 offen offset:3072 lds
    s_add_u32 s70, s63, 497664
    s_mov_b32 m0, 86272
    s_nop 0
    buffer_load_dwordx4 v14, s[48:51], s70 offen offset:0 lds
    buffer_load_dwordx4 v15, s[48:51], s70 offen offset:1024 lds
    buffer_load_dwordx4 v16, s[48:51], s70 offen offset:2048 lds
    buffer_load_dwordx4 v17, s[48:51], s70 offen offset:3072 lds
    s_add_u32 s69, s62, 82176
    s_mov_b32 m0, 73984
    s_nop 0
    buffer_load_dwordx4 v4, s[44:47], s69 offen offset:0 lds
    buffer_load_dwordx4 v5, s[44:47], s69 offen offset:1024 lds
    buffer_load_dwordx4 v6, s[44:47], s69 offen offset:2048 lds
    buffer_load_dwordx4 v7, s[44:47], s69 offen offset:3072 lds
    s_add_u32 s70, s63, 552960
    s_mov_b32 m0, 90368
    s_nop 0
    buffer_load_dwordx4 v14, s[48:51], s70 offen offset:0 lds
    buffer_load_dwordx4 v15, s[48:51], s70 offen offset:1024 lds
    buffer_load_dwordx4 v16, s[48:51], s70 offen offset:2048 lds
    buffer_load_dwordx4 v17, s[48:51], s70 offen offset:3072 lds
    s_add_u32 s69, s62, 123136
    s_mov_b32 m0, 78080
    s_nop 0
    buffer_load_dwordx4 v4, s[44:47], s69 offen offset:0 lds
    buffer_load_dwordx4 v5, s[44:47], s69 offen offset:1024 lds
    buffer_load_dwordx4 v6, s[44:47], s69 offen offset:2048 lds
    buffer_load_dwordx4 v7, s[44:47], s69 offen offset:3072 lds
    s_add_u32 s70, s63, 608256
    s_mov_b32 m0, 94464
    s_nop 0
    buffer_load_dwordx4 v14, s[48:51], s70 offen offset:0 lds
    buffer_load_dwordx4 v15, s[48:51], s70 offen offset:1024 lds
    buffer_load_dwordx4 v16, s[48:51], s70 offen offset:2048 lds
    buffer_load_dwordx4 v17, s[48:51], s70 offen offset:3072 lds
    s_waitcnt vmcnt(32)
    s_barrier
    s_cmp_eq_u32 s66, 7
    s_cselect_b32 s64, 1280, 0
    s_cselect_b32 s65, 2211840, 0
    s_sub_u32 s62, s62, s64
    s_sub_u32 s63, s63, s65
    s_add_u32 s69, s62, 384
    s_mov_b32 m0, 256
    s_nop 0
    buffer_load_dwordx4 v4, s[44:47], s69 offen offset:0 lds
    buffer_load_dwordx4 v5, s[44:47], s69 offen offset:1024 lds
    buffer_load_dwordx4 v6, s[44:47], s69 offen offset:2048 lds
    buffer_load_dwordx4 v7, s[44:47], s69 offen offset:3072 lds
    s_add_u32 s70, s63, 663552
    s_mov_b32 m0, 16640
    s_nop 0
    buffer_load_dwordx4 v14, s[48:51], s70 offen offset:0 lds
    buffer_load_dwordx4 v15, s[48:51], s70 offen offset:1024 lds
    buffer_load_dwordx4 v16, s[48:51], s70 offen offset:2048 lds
    buffer_load_dwordx4 v17, s[48:51], s70 offen offset:3072 lds
    s_add_u32 s69, s62, 41344
    s_mov_b32 m0, 4352
    s_nop 0
    buffer_load_dwordx4 v4, s[44:47], s69 offen offset:0 lds
    buffer_load_dwordx4 v5, s[44:47], s69 offen offset:1024 lds
    buffer_load_dwordx4 v6, s[44:47], s69 offen offset:2048 lds
    buffer_load_dwordx4 v7, s[44:47], s69 offen offset:3072 lds
    s_add_u32 s70, s63, 718848
    s_mov_b32 m0, 20736
    s_nop 0
    buffer_load_dwordx4 v14, s[48:51], s70 offen offset:0 lds
    buffer_load_dwordx4 v15, s[48:51], s70 offen offset:1024 lds
    buffer_load_dwordx4 v16, s[48:51], s70 offen offset:2048 lds
    buffer_load_dwordx4 v17, s[48:51], s70 offen offset:3072 lds
    s_add_u32 s69, s62, 82304
    s_mov_b32 m0, 8448
    s_nop 0
    buffer_load_dwordx4 v4, s[44:47], s69 offen offset:0 lds
    buffer_load_dwordx4 v5, s[44:47], s69 offen offset:1024 lds
    buffer_load_dwordx4 v6, s[44:47], s69 offen offset:2048 lds
    buffer_load_dwordx4 v7, s[44:47], s69 offen offset:3072 lds
    s_add_u32 s70, s63, 774144
    s_mov_b32 m0, 24832
    s_nop 0
    buffer_load_dwordx4 v14, s[48:51], s70 offen offset:0 lds
    buffer_load_dwordx4 v15, s[48:51], s70 offen offset:1024 lds
    buffer_load_dwordx4 v16, s[48:51], s70 offen offset:2048 lds
    buffer_load_dwordx4 v17, s[48:51], s70 offen offset:3072 lds
    s_add_u32 s69, s62, 123264
    s_mov_b32 m0, 12544
    s_nop 0
    buffer_load_dwordx4 v4, s[44:47], s69 offen offset:0 lds
    buffer_load_dwordx4 v5, s[44:47], s69 offen offset:1024 lds
    buffer_load_dwordx4 v6, s[44:47], s69 offen offset:2048 lds
    buffer_load_dwordx4 v7, s[44:47], s69 offen offset:3072 lds
    s_add_u32 s70, s63, 829440
    s_mov_b32 m0, 28928
    s_nop 0
    buffer_load_dwordx4 v14, s[48:51], s70 offen offset:0 lds
    buffer_load_dwordx4 v15, s[48:51], s70 offen offset:1024 lds
    buffer_load_dwordx4 v16, s[48:51], s70 offen offset:2048 lds
    buffer_load_dwordx4 v17, s[48:51], s70 offen offset:3072 lds
    s_waitcnt vmcnt(32)
    s_barrier
    s_cmp_eq_u32 s66, 6
    s_cselect_b32 s64, 1280, 0
    s_cselect_b32 s65, 2211840, 0
    s_sub_u32 s62, s62, s64
    s_sub_u32 s63, s63, s65
    s_add_u32 s69, s62, 512
    s_mov_b32 m0, 33024
    s_nop 0
    buffer_load_dwordx4 v4, s[44:47], s69 offen offset:0 lds
    buffer_load_dwordx4 v5, s[44:47], s69 offen offset:1024 lds
    buffer_load_dwordx4 v6, s[44:47], s69 offen offset:2048 lds
    buffer_load_dwordx4 v7, s[44:47], s69 offen offset:3072 lds
    s_add_u32 s70, s63, 884736
    s_mov_b32 m0, 49408
    s_nop 0
    buffer_load_dwordx4 v14, s[48:51], s70 offen offset:0 lds
    buffer_load_dwordx4 v15, s[48:51], s70 offen offset:1024 lds
    buffer_load_dwordx4 v16, s[48:51], s70 offen offset:2048 lds
    buffer_load_dwordx4 v17, s[48:51], s70 offen offset:3072 lds
    s_add_u32 s69, s62, 41472
    s_mov_b32 m0, 37120
    s_nop 0
    buffer_load_dwordx4 v4, s[44:47], s69 offen offset:0 lds
    buffer_load_dwordx4 v5, s[44:47], s69 offen offset:1024 lds
    buffer_load_dwordx4 v6, s[44:47], s69 offen offset:2048 lds
    buffer_load_dwordx4 v7, s[44:47], s69 offen offset:3072 lds
    s_add_u32 s70, s63, 940032
    s_mov_b32 m0, 53504
    s_nop 0
    buffer_load_dwordx4 v14, s[48:51], s70 offen offset:0 lds
    buffer_load_dwordx4 v15, s[48:51], s70 offen offset:1024 lds
    buffer_load_dwordx4 v16, s[48:51], s70 offen offset:2048 lds
    buffer_load_dwordx4 v17, s[48:51], s70 offen offset:3072 lds
    s_add_u32 s69, s62, 82432
    s_mov_b32 m0, 41216
    s_nop 0
    buffer_load_dwordx4 v4, s[44:47], s69 offen offset:0 lds
    buffer_load_dwordx4 v5, s[44:47], s69 offen offset:1024 lds
    buffer_load_dwordx4 v6, s[44:47], s69 offen offset:2048 lds
    buffer_load_dwordx4 v7, s[44:47], s69 offen offset:3072 lds
    s_add_u32 s70, s63, 995328
    s_mov_b32 m0, 57600
    s_nop 0
    buffer_load_dwordx4 v14, s[48:51], s70 offen offset:0 lds
    buffer_load_dwordx4 v15, s[48:51], s70 offen offset:1024 lds
    buffer_load_dwordx4 v16, s[48:51], s70 offen offset:2048 lds
    buffer_load_dwordx4 v17, s[48:51], s70 offen offset:3072 lds
    s_add_u32 s69, s62, 123392
    s_mov_b32 m0, 45312
    s_nop 0
    buffer_load_dwordx4 v4, s[44:47], s69 offen offset:0 lds
    buffer_load_dwordx4 v5, s[44:47], s69 offen offset:1024 lds
    buffer_load_dwordx4 v6, s[44:47], s69 offen offset:2048 lds
    buffer_load_dwordx4 v7, s[44:47], s69 offen offset:3072 lds
    s_add_u32 s70, s63, 1050624
    s_mov_b32 m0, 61696
    s_nop 0
    buffer_load_dwordx4 v14, s[48:51], s70 offen offset:0 lds
    buffer_load_dwordx4 v15, s[48:51], s70 offen offset:1024 lds
    buffer_load_dwordx4 v16, s[48:51], s70 offen offset:2048 lds
    buffer_load_dwordx4 v17, s[48:51], s70 offen offset:3072 lds
    s_waitcnt vmcnt(32)
    s_barrier
    s_cmp_eq_u32 s66, 5
    s_cselect_b32 s64, 1280, 0
    s_cselect_b32 s65, 2211840, 0
    s_sub_u32 s62, s62, s64
    s_sub_u32 s63, s63, s65
    s_add_u32 s69, s62, 640
    s_mov_b32 m0, 65792
    s_nop 0
    buffer_load_dwordx4 v4, s[44:47], s69 offen offset:0 lds
    buffer_load_dwordx4 v5, s[44:47], s69 offen offset:1024 lds
    buffer_load_dwordx4 v6, s[44:47], s69 offen offset:2048 lds
    buffer_load_dwordx4 v7, s[44:47], s69 offen offset:3072 lds
    s_add_u32 s70, s63, 1105920
    s_mov_b32 m0, 82176
    s_nop 0
    buffer_load_dwordx4 v14, s[48:51], s70 offen offset:0 lds
    buffer_load_dwordx4 v15, s[48:51], s70 offen offset:1024 lds
    buffer_load_dwordx4 v16, s[48:51], s70 offen offset:2048 lds
    buffer_load_dwordx4 v17, s[48:51], s70 offen offset:3072 lds
    s_add_u32 s69, s62, 41600
    s_mov_b32 m0, 69888
    s_nop 0
    buffer_load_dwordx4 v4, s[44:47], s69 offen offset:0 lds
    buffer_load_dwordx4 v5, s[44:47], s69 offen offset:1024 lds
    buffer_load_dwordx4 v6, s[44:47], s69 offen offset:2048 lds
    buffer_load_dwordx4 v7, s[44:47], s69 offen offset:3072 lds
    s_add_u32 s70, s63, 1161216
    s_mov_b32 m0, 86272
    s_nop 0
    buffer_load_dwordx4 v14, s[48:51], s70 offen offset:0 lds
    buffer_load_dwordx4 v15, s[48:51], s70 offen offset:1024 lds
    buffer_load_dwordx4 v16, s[48:51], s70 offen offset:2048 lds
    buffer_load_dwordx4 v17, s[48:51], s70 offen offset:3072 lds
    s_add_u32 s69, s62, 82560
    s_mov_b32 m0, 73984
    s_nop 0
    buffer_load_dwordx4 v4, s[44:47], s69 offen offset:0 lds
    buffer_load_dwordx4 v5, s[44:47], s69 offen offset:1024 lds
    buffer_load_dwordx4 v6, s[44:47], s69 offen offset:2048 lds
    buffer_load_dwordx4 v7, s[44:47], s69 offen offset:3072 lds
    s_add_u32 s70, s63, 1216512
    s_mov_b32 m0, 90368
    s_nop 0
    buffer_load_dwordx4 v14, s[48:51], s70 offen offset:0 lds
    buffer_load_dwordx4 v15, s[48:51], s70 offen offset:1024 lds
    buffer_load_dwordx4 v16, s[48:51], s70 offen offset:2048 lds
    buffer_load_dwordx4 v17, s[48:51], s70 offen offset:3072 lds
    s_add_u32 s69, s62, 123520
    s_mov_b32 m0, 78080
    s_nop 0
    buffer_load_dwordx4 v4, s[44:47], s69 offen offset:0 lds
    buffer_load_dwordx4 v5, s[44:47], s69 offen offset:1024 lds
    buffer_load_dwordx4 v6, s[44:47], s69 offen offset:2048 lds
    buffer_load_dwordx4 v7, s[44:47], s69 offen offset:3072 lds
    s_add_u32 s70, s63, 1271808
    s_mov_b32 m0, 94464
    s_nop 0
    buffer_load_dwordx4 v14, s[48:51], s70 offen offset:0 lds
    buffer_load_dwordx4 v15, s[48:51], s70 offen offset:1024 lds
    buffer_load_dwordx4 v16, s[48:51], s70 offen offset:2048 lds
    buffer_load_dwordx4 v17, s[48:51], s70 offen offset:3072 lds
    s_waitcnt vmcnt(32)
    s_barrier
    s_cmp_eq_u32 s66, 4
    s_cselect_b32 s64, 1280, 0
    s_cselect_b32 s65, 2211840, 0
    s_sub_u32 s62, s62, s64
    s_sub_u32 s63, s63, s65
    s_add_u32 s69, s62, 768
    s_mov_b32 m0, 256
    s_nop 0
    buffer_load_dwordx4 v4, s[44:47], s69 offen offset:0 lds
    buffer_load_dwordx4 v5, s[44:47], s69 offen offset:1024 lds
    buffer_load_dwordx4 v6, s[44:47], s69 offen offset:2048 lds
    buffer_load_dwordx4 v7, s[44:47], s69 offen offset:3072 lds
    s_add_u32 s70, s63, 1327104
    s_mov_b32 m0, 16640
    s_nop 0
    buffer_load_dwordx4 v14, s[48:51], s70 offen offset:0 lds
    buffer_load_dwordx4 v15, s[48:51], s70 offen offset:1024 lds
    buffer_load_dwordx4 v16, s[48:51], s70 offen offset:2048 lds
    buffer_load_dwordx4 v17, s[48:51], s70 offen offset:3072 lds
    s_add_u32 s69, s62, 41728
    s_mov_b32 m0, 4352
    s_nop 0
    buffer_load_dwordx4 v4, s[44:47], s69 offen offset:0 lds
    buffer_load_dwordx4 v5, s[44:47], s69 offen offset:1024 lds
    buffer_load_dwordx4 v6, s[44:47], s69 offen offset:2048 lds
    buffer_load_dwordx4 v7, s[44:47], s69 offen offset:3072 lds
    s_add_u32 s70, s63, 1382400
    s_mov_b32 m0, 20736
    s_nop 0
    buffer_load_dwordx4 v14, s[48:51], s70 offen offset:0 lds
    buffer_load_dwordx4 v15, s[48:51], s70 offen offset:1024 lds
    buffer_load_dwordx4 v16, s[48:51], s70 offen offset:2048 lds
    buffer_load_dwordx4 v17, s[48:51], s70 offen offset:3072 lds
    s_add_u32 s69, s62, 82688
    s_mov_b32 m0, 8448
    s_nop 0
    buffer_load_dwordx4 v4, s[44:47], s69 offen offset:0 lds
    buffer_load_dwordx4 v5, s[44:47], s69 offen offset:1024 lds
    buffer_load_dwordx4 v6, s[44:47], s69 offen offset:2048 lds
    buffer_load_dwordx4 v7, s[44:47], s69 offen offset:3072 lds
    s_add_u32 s70, s63, 1437696
    s_mov_b32 m0, 24832
    s_nop 0
    buffer_load_dwordx4 v14, s[48:51], s70 offen offset:0 lds
    buffer_load_dwordx4 v15, s[48:51], s70 offen offset:1024 lds
    buffer_load_dwordx4 v16, s[48:51], s70 offen offset:2048 lds
    buffer_load_dwordx4 v17, s[48:51], s70 offen offset:3072 lds
    s_add_u32 s69, s62, 123648
    s_mov_b32 m0, 12544
    s_nop 0
    buffer_load_dwordx4 v4, s[44:47], s69 offen offset:0 lds
    buffer_load_dwordx4 v5, s[44:47], s69 offen offset:1024 lds
    buffer_load_dwordx4 v6, s[44:47], s69 offen offset:2048 lds
    buffer_load_dwordx4 v7, s[44:47], s69 offen offset:3072 lds
    s_add_u32 s70, s63, 1492992
    s_mov_b32 m0, 28928
    s_nop 0
    buffer_load_dwordx4 v14, s[48:51], s70 offen offset:0 lds
    buffer_load_dwordx4 v15, s[48:51], s70 offen offset:1024 lds
    buffer_load_dwordx4 v16, s[48:51], s70 offen offset:2048 lds
    buffer_load_dwordx4 v17, s[48:51], s70 offen offset:3072 lds
    s_waitcnt vmcnt(32)
    s_barrier
    s_cmp_eq_u32 s66, 3
    s_cselect_b32 s64, 1280, 0
    s_cselect_b32 s65, 2211840, 0
    s_sub_u32 s62, s62, s64
    s_sub_u32 s63, s63, s65
    s_add_u32 s69, s62, 896
    s_mov_b32 m0, 33024
    s_nop 0
    buffer_load_dwordx4 v4, s[44:47], s69 offen offset:0 lds
    buffer_load_dwordx4 v5, s[44:47], s69 offen offset:1024 lds
    buffer_load_dwordx4 v6, s[44:47], s69 offen offset:2048 lds
    buffer_load_dwordx4 v7, s[44:47], s69 offen offset:3072 lds
    s_add_u32 s70, s63, 1548288
    s_mov_b32 m0, 49408
    s_nop 0
    buffer_load_dwordx4 v14, s[48:51], s70 offen offset:0 lds
    buffer_load_dwordx4 v15, s[48:51], s70 offen offset:1024 lds
    buffer_load_dwordx4 v16, s[48:51], s70 offen offset:2048 lds
    buffer_load_dwordx4 v17, s[48:51], s70 offen offset:3072 lds
    s_add_u32 s69, s62, 41856
    s_mov_b32 m0, 37120
    s_nop 0
    buffer_load_dwordx4 v4, s[44:47], s69 offen offset:0 lds
    buffer_load_dwordx4 v5, s[44:47], s69 offen offset:1024 lds
    buffer_load_dwordx4 v6, s[44:47], s69 offen offset:2048 lds
    buffer_load_dwordx4 v7, s[44:47], s69 offen offset:3072 lds
    s_add_u32 s70, s63, 1603584
    s_mov_b32 m0, 53504
    s_nop 0
    buffer_load_dwordx4 v14, s[48:51], s70 offen offset:0 lds
    buffer_load_dwordx4 v15, s[48:51], s70 offen offset:1024 lds
    buffer_load_dwordx4 v16, s[48:51], s70 offen offset:2048 lds
    buffer_load_dwordx4 v17, s[48:51], s70 offen offset:3072 lds
    s_add_u32 s69, s62, 82816
    s_mov_b32 m0, 41216
    s_nop 0
    buffer_load_dwordx4 v4, s[44:47], s69 offen offset:0 lds
    buffer_load_dwordx4 v5, s[44:47], s69 offen offset:1024 lds
    buffer_load_dwordx4 v6, s[44:47], s69 offen offset:2048 lds
    buffer_load_dwordx4 v7, s[44:47], s69 offen offset:3072 lds
    s_add_u32 s70, s63, 1658880
    s_mov_b32 m0, 57600
    s_nop 0
    buffer_load_dwordx4 v14, s[48:51], s70 offen offset:0 lds
    buffer_load_dwordx4 v15, s[48:51], s70 offen offset:1024 lds
    buffer_load_dwordx4 v16, s[48:51], s70 offen offset:2048 lds
    buffer_load_dwordx4 v17, s[48:51], s70 offen offset:3072 lds
    s_add_u32 s69, s62, 123776
    s_mov_b32 m0, 45312
    s_nop 0
    buffer_load_dwordx4 v4, s[44:47], s69 offen offset:0 lds
    buffer_load_dwordx4 v5, s[44:47], s69 offen offset:1024 lds
    buffer_load_dwordx4 v6, s[44:47], s69 offen offset:2048 lds
    buffer_load_dwordx4 v7, s[44:47], s69 offen offset:3072 lds
    s_add_u32 s70, s63, 1714176
    s_mov_b32 m0, 61696
    s_nop 0
    buffer_load_dwordx4 v14, s[48:51], s70 offen offset:0 lds
    buffer_load_dwordx4 v15, s[48:51], s70 offen offset:1024 lds
    buffer_load_dwordx4 v16, s[48:51], s70 offen offset:2048 lds
    buffer_load_dwordx4 v17, s[48:51], s70 offen offset:3072 lds
    s_waitcnt vmcnt(32)
    s_barrier
    s_cmp_eq_u32 s66, 2
    s_cselect_b32 s64, 1280, 0
    s_cselect_b32 s65, 2211840, 0
    s_sub_u32 s62, s62, s64
    s_sub_u32 s63, s63, s65
    s_add_u32 s69, s62, 1024
    s_mov_b32 m0, 65792
    s_nop 0
    buffer_load_dwordx4 v4, s[44:47], s69 offen offset:0 lds
    buffer_load_dwordx4 v5, s[44:47], s69 offen offset:1024 lds
    buffer_load_dwordx4 v6, s[44:47], s69 offen offset:2048 lds
    buffer_load_dwordx4 v7, s[44:47], s69 offen offset:3072 lds
    s_add_u32 s70, s63, 1769472
    s_mov_b32 m0, 82176
    s_nop 0
    buffer_load_dwordx4 v14, s[48:51], s70 offen offset:0 lds
    buffer_load_dwordx4 v15, s[48:51], s70 offen offset:1024 lds
    buffer_load_dwordx4 v16, s[48:51], s70 offen offset:2048 lds
    buffer_load_dwordx4 v17, s[48:51], s70 offen offset:3072 lds
    s_add_u32 s69, s62, 41984
    s_mov_b32 m0, 69888
    s_nop 0
    buffer_load_dwordx4 v4, s[44:47], s69 offen offset:0 lds
    buffer_load_dwordx4 v5, s[44:47], s69 offen offset:1024 lds
    buffer_load_dwordx4 v6, s[44:47], s69 offen offset:2048 lds
    buffer_load_dwordx4 v7, s[44:47], s69 offen offset:3072 lds
    s_add_u32 s70, s63, 1824768
    s_mov_b32 m0, 86272
    s_nop 0
    buffer_load_dwordx4 v14, s[48:51], s70 offen offset:0 lds
    buffer_load_dwordx4 v15, s[48:51], s70 offen offset:1024 lds
    buffer_load_dwordx4 v16, s[48:51], s70 offen offset:2048 lds
    buffer_load_dwordx4 v17, s[48:51], s70 offen offset:3072 lds
    s_add_u32 s69, s62, 82944
    s_mov_b32 m0, 73984
    s_nop 0
    buffer_load_dwordx4 v4, s[44:47], s69 offen offset:0 lds
    buffer_load_dwordx4 v5, s[44:47], s69 offen offset:1024 lds
    buffer_load_dwordx4 v6, s[44:47], s69 offen offset:2048 lds
    buffer_load_dwordx4 v7, s[44:47], s69 offen offset:3072 lds
    s_add_u32 s70, s63, 1880064
    s_mov_b32 m0, 90368
    s_nop 0
    buffer_load_dwordx4 v14, s[48:51], s70 offen offset:0 lds
    buffer_load_dwordx4 v15, s[48:51], s70 offen offset:1024 lds
    buffer_load_dwordx4 v16, s[48:51], s70 offen offset:2048 lds
    buffer_load_dwordx4 v17, s[48:51], s70 offen offset:3072 lds
    s_add_u32 s69, s62, 123904
    s_mov_b32 m0, 78080
    s_nop 0
    buffer_load_dwordx4 v4, s[44:47], s69 offen offset:0 lds
    buffer_load_dwordx4 v5, s[44:47], s69 offen offset:1024 lds
    buffer_load_dwordx4 v6, s[44:47], s69 offen offset:2048 lds
    buffer_load_dwordx4 v7, s[44:47], s69 offen offset:3072 lds
    s_add_u32 s70, s63, 1935360
    s_mov_b32 m0, 94464
    s_nop 0
    buffer_load_dwordx4 v14, s[48:51], s70 offen offset:0 lds
    buffer_load_dwordx4 v15, s[48:51], s70 offen offset:1024 lds
    buffer_load_dwordx4 v16, s[48:51], s70 offen offset:2048 lds
    buffer_load_dwordx4 v17, s[48:51], s70 offen offset:3072 lds
    s_waitcnt vmcnt(32)
    s_barrier
    s_cmp_eq_u32 s66, 1
    s_cselect_b32 s64, 1280, 0
    s_cselect_b32 s65, 2211840, 0
    s_sub_u32 s62, s62, s64
    s_sub_u32 s63, s63, s65
    s_add_u32 s69, s62, 1152
    s_mov_b32 m0, 256
    s_nop 0
    buffer_load_dwordx4 v4, s[44:47], s69 offen offset:0 lds
    buffer_load_dwordx4 v5, s[44:47], s69 offen offset:1024 lds
    buffer_load_dwordx4 v6, s[44:47], s69 offen offset:2048 lds
    buffer_load_dwordx4 v7, s[44:47], s69 offen offset:3072 lds
    s_add_u32 s70, s63, 1990656
    s_mov_b32 m0, 16640
    s_nop 0
    buffer_load_dwordx4 v14, s[48:51], s70 offen offset:0 lds
    buffer_load_dwordx4 v15, s[48:51], s70 offen offset:1024 lds
    buffer_load_dwordx4 v16, s[48:51], s70 offen offset:2048 lds
    buffer_load_dwordx4 v17, s[48:51], s70 offen offset:3072 lds
    s_add_u32 s69, s62, 42112
    s_mov_b32 m0, 4352
    s_nop 0
    buffer_load_dwordx4 v4, s[44:47], s69 offen offset:0 lds
    buffer_load_dwordx4 v5, s[44:47], s69 offen offset:1024 lds
    buffer_load_dwordx4 v6, s[44:47], s69 offen offset:2048 lds
    buffer_load_dwordx4 v7, s[44:47], s69 offen offset:3072 lds
    s_add_u32 s70, s63, 2045952
    s_mov_b32 m0, 20736
    s_nop 0
    buffer_load_dwordx4 v14, s[48:51], s70 offen offset:0 lds
    buffer_load_dwordx4 v15, s[48:51], s70 offen offset:1024 lds
    buffer_load_dwordx4 v16, s[48:51], s70 offen offset:2048 lds
    buffer_load_dwordx4 v17, s[48:51], s70 offen offset:3072 lds
    s_add_u32 s69, s62, 83072
    s_mov_b32 m0, 8448
    s_nop 0
    buffer_load_dwordx4 v4, s[44:47], s69 offen offset:0 lds
    buffer_load_dwordx4 v5, s[44:47], s69 offen offset:1024 lds
    buffer_load_dwordx4 v6, s[44:47], s69 offen offset:2048 lds
    buffer_load_dwordx4 v7, s[44:47], s69 offen offset:3072 lds
    s_add_u32 s70, s63, 2101248
    s_mov_b32 m0, 24832
    s_nop 0
    buffer_load_dwordx4 v14, s[48:51], s70 offen offset:0 lds
    buffer_load_dwordx4 v15, s[48:51], s70 offen offset:1024 lds
    buffer_load_dwordx4 v16, s[48:51], s70 offen offset:2048 lds
    buffer_load_dwordx4 v17, s[48:51], s70 offen offset:3072 lds
    s_add_u32 s69, s62, 124032
    s_mov_b32 m0, 12544
    s_nop 0
    buffer_load_dwordx4 v4, s[44:47], s69 offen offset:0 lds
    buffer_load_dwordx4 v5, s[44:47], s69 offen offset:1024 lds
    buffer_load_dwordx4 v6, s[44:47], s69 offen offset:2048 lds
    buffer_load_dwordx4 v7, s[44:47], s69 offen offset:3072 lds
    s_add_u32 s70, s63, 2156544
    s_mov_b32 m0, 28928
    s_nop 0
    buffer_load_dwordx4 v14, s[48:51], s70 offen offset:0 lds
    buffer_load_dwordx4 v15, s[48:51], s70 offen offset:1024 lds
    buffer_load_dwordx4 v16, s[48:51], s70 offen offset:2048 lds
    buffer_load_dwordx4 v17, s[48:51], s70 offen offset:3072 lds
    s_waitcnt vmcnt(32)
    s_barrier
    buffer_load_dword v36, v35, s[52:55], 0 offen offset:252 sc1
    s_lshl_b32 s73, s60, 10
    s_add_u32 s73, s73, 15056896
    buffer_load_dwordx4 v[40:43], v30, s[40:43], s73 offen sc1
    s_mov_b32 s48, s28
    s_and_b32 s49, s29, 0xffff
    s_mov_b32 s50, 2211840
    s_mov_b32 s51, 0x20000
    s_sub_u32 s68, s2, 32
    s_lshr_b32 s73, s68, 2
    s_and_b32 s68, s68, 3
    s_mul_i32 s70, s73, 40960
    s_mul_i32 s71, s68, 320
    s_add_u32 s70, s70, s71
    s_add_u32 s71, s70, 0
    s_mov_b32 m0, 98560
    s_nop 0
    buffer_load_dwordx4 v24, s[48:51], s71 offen nt lds
    s_add_u32 s71, s70, 64
    s_mov_b32 m0, 99584
    s_nop 0
    buffer_load_dwordx4 v24, s[48:51], s71 offen nt lds
    s_add_u32 s71, s70, 128
    s_mov_b32 m0, 100608
    s_nop 0
    buffer_load_dwordx4 v24, s[48:51], s71 offen nt lds
    s_add_u32 s71, s70, 192
    s_mov_b32 m0, 101632
    s_nop 0
    buffer_load_dwordx4 v24, s[48:51], s71 offen nt lds
    s_add_u32 s71, s70, 256
    s_mov_b32 m0, 102656
    s_nop 0
    buffer_load_dwordx4 v24, s[48:51], s71 offen nt lds
    s_add_u32 s71, s70, 20480
    s_mov_b32 m0, 103680
    s_nop 0
    buffer_load_dwordx4 v24, s[48:51], s71 offen nt lds
    s_add_u32 s71, s70, 20544
    s_mov_b32 m0, 104704
    s_nop 0
    buffer_load_dwordx4 v24, s[48:51], s71 offen nt lds
    s_add_u32 s71, s70, 20608
    s_mov_b32 m0, 105728
    s_nop 0
    buffer_load_dwordx4 v24, s[48:51], s71 offen nt lds
    s_add_u32 s71, s70, 20672
    s_mov_b32 m0, 106752
    s_nop 0
    buffer_load_dwordx4 v24, s[48:51], s71 offen nt lds
    s_add_u32 s71, s70, 20736
    s_mov_b32 m0, 107776
    s_nop 0
    buffer_load_dwordx4 v24, s[48:51], s71 offen nt lds
    s_waitcnt vmcnt(12)
    s_barrier
    s_waitcnt vmcnt(10)
L_ld_rec:
    s_mov_b32 s76, 0
L_rec_chk:
    v_readfirstlane_b32 s59, v36
    v_xor_b32 v39, v36, v41
    v_xor_b32 v52, v36, v43
    v_or_b32 v39, v39, v52
    v_cmp_ne_u32 vcc, 0, v39
    s_cmp_eq_u32 s59, 0
    s_cbranch_scc1 L_rec_again
    s_cmp_eq_u64 vcc, 0
    s_cbranch_scc1 L_rec_ok
L_rec_again:
    s_add_u32 s76, s76, 1
    s_cmp_ge_u32 s76, 20000
    s_cbranch_scc1 L_rec_giveup
    s_sleep 10
    buffer_load_dword v36, v35, s[52:55], 0 offen offset:252 sc1
    s_lshl_b32 s73, s60, 10
    s_add_u32 s73, s73, 15056896
    buffer_load_dwordx4 v[40:43], v30, s[40:43], s73 offen sc1
    s_waitcnt vmcnt(0)
    s_branch L_rec_chk
L_rec_giveup:
    s_or_b32 s59, s59, 1
L_rec_ok:
    s_mov_b32 s73, 0x01000100
    v_lshrrev_b32 v41, 16, v40
    v_lshrrev_b32 v43, 16, v42
    v_perm_b32 v40, v40, v40, s73
    v_perm_b32 v42, v42, v42, s73
    v_add_u32 v53, 65792, v30
    s_cmp_ge_u32 s39, 4
    s_cbranch_scc1 L_rec_free
    s_mov_b32 s77, 0
L_lw1:
    ds_read_b32 v23, v20
    s_waitcnt lgkmcnt(0)
    v_cmp_le_u32 vcc, 7, v23
    s_nop 0
    s_cmp_eq_u64 vcc, -1
    s_cbranch_scc1 L_lx1
    s_add_u32 s77, s77, 1
    s_cmp_ge_u32 s77, 160000
    s_cbranch_scc1 L_lx1
    s_sleep 1
    s_branch L_lw1
L_lx1:
L_rec_free:
    ds_write_b128 v53, v[40:43]
    v_mov_b32 v22, 36
    v_mov_b32 v23, s59
    s_mov_b64 exec, 1
    ds_write_b32 v22, v23
    s_mov_b64 exec, -1
    v_mov_b32 v22, 32
    v_mov_b32 v23, s59
    s_mov_b64 exec, 1
    ds_write_b32 v22, v23
    s_mov_b64 exec, -1
    s_cmp_lt_u32 s39, 4
    s_cbranch_scc1 L_rec_now
    s_sub_u32 s68, s2, 32
    s_lshr_b32 s73, s68, 2
    s_and_b32 s68, s68, 3
    s_mul_i32 s70, s68, 108
    s_add_u32 s70, s70, s73
    s_mul_i32 s70, s70, 5120
    s_add_u32 s70, s70, 12845056
    s_cmp_lt_u32 s2, 248
    s_cselect_b32 s70, s70, 0x70000000
    s_add_u32 s71, s70, 276480
    s_lshl_b32 s75, s68, 6
    s_add_u32 s75, s75, s73
    s_lshl_b32 s75, s75, 7
    s_add_u32 s75, s75, 15126528
    v_lshrrev_b32 v26, 2, v1
    v_lshlrev_b32 v26, 6, v26
    v_and_b32 v27, 3, v1
    v_lshl_add_u32 v26, v27, 3, v26
    v_add_u32 v26, 98560, v26
    v_add_u32 v28, 4096, v30
    s_waitcnt vmcnt(0)
    ds_read_b64_tr_b16 v[64:65], v26 offset:0
    ds_read_b64_tr_b16 v[66:67], v26 offset:5120
    ds_read_b64_tr_b16 v[68:69], v26 offset:32
    ds_read_b64_tr_b16 v[70:71], v26 offset:5152
    ds_read_b64_tr_b16 v[72:73], v26 offset:1024
    ds_read_b64_tr_b16 v[74:75], v26 offset:6144
    ds_read_b64_tr_b16 v[76:77], v26 offset:1056
    ds_read_b64_tr_b16 v[78:79], v26 offset:6176
    ds_read_b64_tr_b16 v[80:81], v26 offset:2048
    ds_read_b64_tr_b16 v[82:83], v26 offset:7168
    ds_read_b64_tr_b16 v[84:85], v26 offset:2080
    ds_read_b64_tr_b16 v[86:87], v26 offset:7200
    ds_read_b64_tr_b16 v[88:89], v26 offset:3072
    ds_read_b64_tr_b16 v[90:91], v26 offset:8192
    ds_read_b64_tr_b16 v[92:93], v26 offset:3104
    ds_read_b64_tr_b16 v[94:95], v26 offset:8224
    ds_read_b64_tr_b16 v[96:97], v26 offset:4096
    ds_read_b64_tr_b16 v[98:99], v26 offset:9216
    ds_read_b64_tr_b16 v[100:101], v26 offset:4128
    ds_read_b64_tr_b16 v[102:103], v26 offset:9248
    s_waitcnt lgkmcnt(0)
    buffer_store_dwordx4 v[64:67], v30, s[40:43], s70 offen offset:0 sc1
    buffer_store_dwordx4 v[68:71], v30, s[40:43], s70 offen offset:1024 sc1
    buffer_store_dwordx4 v[72:75], v30, s[40:43], s70 offen offset:2048 sc1
    buffer_store_dwordx4 v[76:79], v30, s[40:43], s70 offen offset:3072 sc1
    buffer_store_dwordx4 v[80:83], v28, s[40:43], s70 offen sc1
    buffer_store_dwordx4 v[84:87], v30, s[40:43], s71 offen offset:0 sc1
    buffer_store_dwordx4 v[88:91], v30, s[40:43], s71 offen offset:1024 sc1
    buffer_store_dwordx4 v[92:95], v30, s[40:43], s71 offen offset:2048 sc1
    buffer_store_dwordx4 v[96:99], v30, s[40:43], s71 offen offset:3072 sc1
    buffer_store_dwordx4 v[100:103], v28, s[40:43], s71 offen sc1
L_rec_now:
    buffer_load_dword v37, v33, s[40:43], s72 offen sc1
    v_and_b32 v20, 3, v1
    v_lshlrev_b32 v20, 2, v20
    v_add_u32 v20, 16, v20
    s_sub_u32 s70, s3, 4
    s_lshr_b32 s71, s70, 1
    v_and_b32 v190, 15, v1
    v_lshrrev_b32 v191, 4, v1
    v_lshlrev_b32 v192, 3, v191
    v_sub_u32 v192, v192, v190
    v_add_u32 v192, 15, v192
    v_and_b32 v193, 3, v192
    v_sub_u32 v192, v192, v193
    v_mul_u32_u24 v193, 4160, v193
    v_lshl_add_u32 v192, v192, 1, v193
    s_mul_i32 s64, s71, 16640
    s_add_u32 s64, s64, 96016
    v_add_u32 v240, s64, v192
    v_lshlrev_b32 v192, 5, v190
    v_lshl_add_u32 v193, v191, 4, v192
    s_mul_i32 s64, s71, 4608
    s_add_u32 s64, s64, 82208
    v_add_u32 v241, s64, v193
    s_sub_u32 s73, 2, s71
    s_mul_i32 s64, s73, 16640
    s_lshl_b32 s69, s70, 7
    s_add_u32 s64, s64, s69
    v_add_u32 v242, s64, v240
    s_mul_i32 s64, s73, 4608
    s_add_u32 s64, s64, s69
    v_add_u32 v243, s64, v241
    s_and_b32 s64, s70, 1
    s_lshl_b32 s64, s64, 8
    v_add_u32 v240, s64, v240
    v_add_u32 v241, s64, v241
    s_lshl_b32 s64, s64, 5
    s_mul_i32 s69, s71, 16640
    s_add_u32 s64, s64, s69
    s_add_u32 s64, s64, 96000
    v_lshl_add_u32 v244, v1, 4, s64
    s_cmp_eq_u32 s75, 0
    s_cbranch_scc1 L_wl_nof
    s_waitcnt vmcnt(1)
    v_lshlrev_b32 v21, 2, v1
    v_mov_b32 v22, s59
    s_mov_b32 exec_hi, 0
    buffer_store_dword v22, v21, s[40:43], s75 offen sc1
    s_mov_b64 exec, -1
    s_waitcnt vmcnt(1)
    s_branch L_wl_f
L_wl_nof:
    s_waitcnt vmcnt(0)
L_wl_f:
    v_cmp_eq_u32 vcc, s59, v37
    s_mov_b32 s74, 0
    s_cmp_eq_u64 vcc, -1
    s_cbranch_scc0 L_wl_r
    v_lshrrev_b32 v54, 3, v1
    v_mul_u32_u24 v54, 82048, v54
    v_and_b32 v55, 7, v1
    v_lshl_add_u32 v55, v55, 4, v54
    s_and_b32 s64, s2, 1
    s_mul_i32 s64, s64, 3
    s_add_u32 s64, s64, s58
    s_mul_i32 s65, s64, 128
    s_mov_b32 m0, 82688
    s_nop 0
    buffer_load_dwordx4 v55, s[40:43], s65 offen sc1 lds
    s_add_u32 s65, s65, 656384
    s_mov_b32 m0, 83712
    s_nop 0
    buffer_load_dwordx4 v55, s[40:43], s65 offen sc1 lds
    s_add_u32 s65, s65, 656384
    s_mov_b32 m0, 84736
    s_nop 0
    buffer_load_dwordx4 v55, s[40:43], s65 offen sc1 lds
    s_add_u32 s65, s65, 656384
    s_mov_b32 m0, 85760
    s_nop 0
    buffer_load_dwordx4 v55, s[40:43], s65 offen sc1 lds
    s_add_u32 s64, s64, 1
    s_mul_i32 s65, s64, 128
    s_mov_b32 m0, 87296
    s_nop 0
    buffer_load_dwordx4 v55, s[40:43], s65 offen sc1 lds
    s_add_u32 s65, s65, 656384
    s_mov_b32 m0, 88320
    s_nop 0
    buffer_load_dwordx4 v55, s[40:43], s65 offen sc1 lds
    s_add_u32 s65, s65, 656384
    s_mov_b32 m0, 89344
    s_nop 0
    buffer_load_dwordx4 v55, s[40:43], s65 offen sc1 lds
    s_add_u32 s65, s65, 656384
    s_mov_b32 m0, 90368
    s_nop 0
    buffer_load_dwordx4 v55, s[40:43], s65 offen sc1 lds
    s_add_u32 s64, s58, 2
    s_mul_i32 s65, s64, 128
    s_mov_b32 m0, 91904
    s_nop 0
    buffer_load_dwordx4 v55, s[40:43], s65 offen sc1 lds
    s_add_u32 s65, s65, 656384
    s_mov_b32 m0, 92928
    s_nop 0
    buffer_load_dwordx4 v55, s[40:43], s65 offen sc1 lds
    s_add_u32 s65, s65, 656384
    s_mov_b32 m0, 93952
    s_nop 0
    buffer_load_dwordx4 v55, s[40:43], s65 offen sc1 lds
    s_add_u32 s65, s65, 656384
    s_mov_b32 m0, 94976
    s_nop 0
    buffer_load_dwordx4 v55, s[40:43], s65 offen sc1 lds
    v_lshlrev_b32 v54, 3, v1
    v_add_u32 v54, 82176, v54
    v_mov_b32 v56, 0
    v_mov_b32 v57, 0
    ds_write_b64 v54, v[56:57] offset:0
    ds_write_b64 v54, v[56:57] offset:4608
    ds_write_b64 v54, v[56:57] offset:9216
    s_mov_b32 s74, 1
L_wl_r:
    s_mov_b32 s77, 0
L_lw2:
    ds_read_b32 v23, v20
    s_waitcnt lgkmcnt(0)
    v_cmp_le_u32 vcc, 11, v23
    s_nop 0
    s_cmp_eq_u64 vcc, -1
    s_cbranch_scc1 L_lx2
    s_add_u32 s77, s77, 1
    s_cmp_ge_u32 s77, 160000
    s_cbranch_scc1 L_lx2
    s_sleep 1
    s_branch L_lw2
L_lx2:
    v_mov_b32 v21, 124
    v_mov_b32 v22, 1
    s_mov_b64 exec, 1
    ds_write_b32 v21, v22
    s_mov_b64 exec, -1
    s_cmp_eq_u32 s74, 1
    s_cbranch_scc1 L_wl_xn
    s_mov_b32 s77, 0
L_gp3:
    buffer_load_dword v37, v33, s[40:43], s72 offen sc1
    s_waitcnt vmcnt(0)
    v_cmp_eq_u32 vcc, s59, v37
    s_nop 0
    s_cmp_eq_u64 vcc, -1
    s_cbranch_scc1 L_gx3
    s_add_u32 s77, s77, 1
    s_cmp_ge_u32 s77, 20000
    s_cbranch_scc1 L_gx3
    s_sleep 8
    s_branch L_gp3
L_gx3:
    v_lshrrev_b32 v54, 3, v1
    v_mul_u32_u24 v54, 82048, v54
    v_and_b32 v55, 7, v1
    v_lshl_add_u32 v55, v55, 4, v54
    s_and_b32 s64, s2, 1
    s_mul_i32 s64, s64, 3
    s_add_u32 s64, s64, s58
    s_mul_i32 s65, s64, 128
    s_mov_b32 m0, 82688
    s_nop 0
    buffer_load_dwordx4 v55, s[40:43], s65 offen sc1 lds
    s_add_u32 s65, s65, 656384
    s_mov_b32 m0, 83712
    s_nop 0
    buffer_load_dwordx4 v55, s[40:43], s65 offen sc1 lds
    s_add_u32 s65, s65, 656384
    s_mov_b32 m0, 84736
    s_nop 0
    buffer_load_dwordx4 v55, s[40:43], s65 offen sc1 lds
    s_add_u32 s65, s65, 656384
    s_mov_b32 m0, 85760
    s_nop 0
    buffer_load_dwordx4 v55, s[40:43], s65 offen sc1 lds
    s_add_u32 s64, s64, 1
    s_mul_i32 s65, s64, 128
    s_mov_b32 m0, 87296
    s_nop 0
    buffer_load_dwordx4 v55, s[40:43], s65 offen sc1 lds
    s_add_u32 s65, s65, 656384
    s_mov_b32 m0, 88320
    s_nop 0
    buffer_load_dwordx4 v55, s[40:43], s65 offen sc1 lds
    s_add_u32 s65, s65, 656384
    s_mov_b32 m0, 89344
    s_nop 0
    buffer_load_dwordx4 v55, s[40:43], s65 offen sc1 lds
    s_add_u32 s65, s65, 656384
    s_mov_b32 m0, 90368
    s_nop 0
    buffer_load_dwordx4 v55, s[40:43], s65 offen sc1 lds
    s_add_u32 s64, s58, 2
    s_mul_i32 s65, s64, 128
    s_mov_b32 m0, 91904
    s_nop 0
    buffer_load_dwordx4 v55, s[40:43], s65 offen sc1 lds
    s_add_u32 s65, s65, 656384
    s_mov_b32 m0, 92928
    s_nop 0
    buffer_load_dwordx4 v55, s[40:43], s65 offen sc1 lds
    s_add_u32 s65, s65, 656384
    s_mov_b32 m0, 93952
    s_nop 0
    buffer_load_dwordx4 v55, s[40:43], s65 offen sc1 lds
    s_add_u32 s65, s65, 656384
    s_mov_b32 m0, 94976
    s_nop 0
    buffer_load_dwordx4 v55, s[40:43], s65 offen sc1 lds
    v_lshlrev_b32 v54, 3, v1
    v_add_u32 v54, 82176, v54
    v_mov_b32 v56, 0
    v_mov_b32 v57, 0
    ds_write_b64 v54, v[56:57] offset:0
    ds_write_b64 v54, v[56:57] offset:4608
    ds_write_b64 v54, v[56:57] offset:9216
L_wl_xn:
    s_mov_b32 s44, s4
    s_and_b32 s45, s5, 0xffff
    s_mov_b32 s46, 2621440
    s_mov_b32 s47, 0x20000
    s_mov_b32 s48, s30
    s_and_b32 s49, s31, 0xffff
    s_mov_b32 s50, 1280
    s_mov_b32 s51, 0x20000
    v_and_b32 v56, 3, v1
    v_lshrrev_b32 v57, 2, v1
    v_mul_u32_u24 v57, 1280, v57
    v_lshlrev_b32 v58, 3, v56
    v_lshlrev_b32 v56, 4, v56
    v_add_u32 v59, v57, v58
    v_add_u32 v57, v57, v56
    s_lshl_b32 s69, s56, 2
    s_add_u32 s69, s69, s3
    s_sub_u32 s69, s69, 4
    s_mul_i32 s69, s69, 20480
    s_mul_i32 s70, s57, 160
    s_add_u32 s69, s69, s70
    buffer_load_dwordx4 v[212:215], v57, s[44:47], s69 offen
    buffer_load_dwordx4 v[216:219], v57, s[44:47], s69 offen offset:64
    buffer_load_dwordx2 v[238:239], v59, s[44:47], s69 offen offset:128
    buffer_load_dwordx4 v[248:251], v56, s[48:51], s70 offen
    buffer_load_dwordx4 v[252:255], v56, s[48:51], s70 offen offset:64
    buffer_load_dwordx2 v[246:247], v58, s[48:51], s70 offen offset:128
    s_waitcnt vmcnt(6)
    v_mov_b32 v21, 60
    v_mov_b32 v22, 12
    s_mov_b64 exec, 1
    ds_write_b32 v21, v22
    s_mov_b64 exec, -1
    s_branch L_conv
    s_nop 0
L_kwave:
    s_setprio 0
    s_sub_u32 s62, s3, 5
    s_mov_b32 s63, s76
    s_mul_i32 s67, s62, 8704
    s_add_u32 s67, s67, 131328
    s_mov_b32 s52, s34
    s_and_b32 s53, s35, 0xffff
    s_mov_b32 s54, 256
    s_mov_b32 s55, 0x20000
    s_cmp_eq_u32 s62, 2
    s_cbranch_scc1 L_k2
    s_cmp_ge_u32 s39, 4
    s_cbranch_scc1 L_kgo
    s_branch L_kgo
L_k2:
    v_mov_b32 v12, 0
    s_cmp_lg_u32 s2, 0
    s_cbranch_scc1 L_k2a
    s_memrealtime s[68:69]
    s_waitcnt lgkmcnt(0)
    s_or_b32 s68, s68, 1
    s_mul_i32 s68, s68, 0x9E3779B1
    v_mov_b32 v13, s68
    s_mov_b64 exec, 1
    buffer_store_dword v13, v12, s[52:55], 0 offen offset:252 sc1
    s_mov_b64 exec, -1
L_k2a:
    s_cmp_ge_u32 s39, 4
    s_cbranch_scc1 L_k2b
    s_mov_b32 s77, 0
L_np4:
    buffer_load_dword v13, v12, s[52:55], 0 offen offset:252 sc1
L_nq4:
    s_add_u32 s77, s77, 1
    s_waitcnt vmcnt(0)
    v_readfirstlane_b32 s59, v13
    s_nop 0
    s_cmp_lg_u32 s59, 0
    s_cbranch_scc1 L_nx4
    s_sleep 4
    s_cmp_lt_u32 s77, 20000
    s_cbranch_scc1 L_np4
    s_mov_b32 s59, 1
L_nx4:
    v_mov_b32 v12, 32
    v_mov_b32 v13, s59
    s_mov_b64 exec, 1
    ds_write_b32 v12, v13
    s_mov_b64 exec, -1
    s_branch L_kgo
L_k2b:
L_kgo:
    v_lshl_add_u32 v10, v1, 3, s67
    v_and_b32 v16, 15, v1
    v_mul_u32_u24 v12, 544, v16
    v_lshrrev_b32 v17, 4, v1
    v_lshl_add_u32 v12, v17, 4, v12
    v_add_u32 v11, s67, v12
    v_lshrrev_b32 v13, 1, v17
    v_and_b32 v14, 1, v17
    v_lshlrev_b32 v220, 8, v13
    v_lshl_add_u32 v220, v16, 4, v220
    v_lshl_add_u32 v220, v14, 3, v220
    v_add_u32 v220, s67, v220
    v_lshlrev_b32 v221, 7, v17
    v_sub_u32 v222, 3, v13
    v_lshlrev_b32 v222, v222, v16
    v_add3_u32 v221, v221, v222, s67
    v_mul_u32_u24 v222, 60, v13
    v_add3_u32 v222, v221, v222, 4
    v_lshlrev_b32 v223, 5, v16
    v_lshl_add_u32 v223, v17, 3, v223
    v_add_u32 v223, s67, v223
    v_cmp_eq_u32 vcc, 0, v1
    v_lshlrev_b32 v18, 1, v1
    v_sub_u32 v224, 1152, v18
    v_bfe_u32 v19, v224, 3, 1
    v_add3_u32 v224, v224, v19, 3
    v_lshrrev_b32 v224, 3, v224
    v_lshl_add_u32 v224, v224, 1, s67
    v_sub_u32 v225, 1151, v18
    v_bfe_u32 v19, v225, 3, 1
    v_add3_u32 v225, v225, v19, 3
    v_lshrrev_b32 v225, 3, v225
    v_lshl_add_u32 v225, v225, 1, s67
    v_sub_u32 v226, 1150, v18
    v_bfe_u32 v19, v226, 3, 1
    v_add3_u32 v226, v226, v19, 3
    v_lshrrev_b32 v226, 3, v226
    v_lshl_add_u32 v226, v226, 1, s67
    v_sub_u32 v227, 640, v18
    v_bfe_u32 v19, v227, 2, 1
    v_add3_u32 v227, v227, v19, 1
    v_lshrrev_b32 v227, 2, v227
    v_lshl_add_u32 v227, v227, 1, s67
    v_sub_u32 v228, 639, v18
    v_bfe_u32 v19, v228, 2, 1
    v_add3_u32 v228, v228, v19, 1
    v_lshrrev_b32 v228, 2, v228
    v_lshl_add_u32 v228, v228, 1, s67
    v_sub_u32 v229, 638, v18
    v_bfe_u32 v19, v229, 2, 1
    v_add3_u32 v229, v229, v19, 1
    v_lshrrev_b32 v229, 2, v229
    v_lshl_add_u32 v229, v229, 1, s67
    v_sub_u32 v230, 384, v18
    v_bfe_u32 v19, v230, 1, 1
    v_add3_u32 v230, v230, v19, 0
    v_lshrrev_b32 v230, 1, v230
    v_lshl_add_u32 v230, v230, 1, s67
    v_sub_u32 v231, 383, v18
    v_bfe_u32 v19, v231, 1, 1
    v_add3_u32 v231, v231, v19, 0
    v_lshrrev_b32 v231, 1, v231
    v_lshl_add_u32 v231, v231, 1, s67
    v_sub_u32 v232, 382, v18
    v_bfe_u32 v19, v232, 1, 1
    v_add3_u32 v232, v232, v19, 0
    v_lshrrev_b32 v232, 1, v232
    v_lshl_add_u32 v232, v232, 1, s67
    v_sub_u32 v233, 128, v18
    v_lshl_add_u32 v233, v233, 1, s67
    v_sub_u32 v234, 127, v18
    v_lshl_add_u32 v234, v234, 1, s67
    v_sub_u32 v235, 126, v18
    v_lshl_add_u32 v235, v235, 1, s67
    v_cndmask_b32 v236, 0, -1, vcc
    s_sub_u32 s70, s3, 4
    s_lshr_b32 s71, s70, 1
    v_and_b32 v190, 15, v1
    v_lshrrev_b32 v191, 4, v1
    v_lshlrev_b32 v192, 3, v191
    v_sub_u32 v192, v192, v190
    v_add_u32 v192, 15, v192
    v_and_b32 v193, 3, v192
    v_sub_u32 v192, v192, v193
    v_mul_u32_u24 v193, 4160, v193
    v_lshl_add_u32 v192, v192, 1, v193
    s_mul_i32 s64, s71, 16640
    s_add_u32 s64, s64, 96016
    v_add_u32 v240, s64, v192
    v_lshlrev_b32 v192, 5, v190
    v_lshl_add_u32 v193, v191, 4, v192
    s_mul_i32 s64, s71, 4608
    s_add_u32 s64, s64, 82208
    v_add_u32 v241, s64, v193
    s_sub_u32 s73, 2, s71
    s_mul_i32 s64, s73, 16640
    s_lshl_b32 s69, s70, 7
    s_add_u32 s64, s64, s69
    v_add_u32 v242, s64, v240
    s_mul_i32 s64, s73, 4608
    s_add_u32 s64, s64, s69
    v_add_u32 v243, s64, v241
    s_and_b32 s64, s70, 1
    s_lshl_b32 s64, s64, 8
    v_add_u32 v240, s64, v240
    v_add_u32 v241, s64, v241
    s_lshl_b32 s64, s64, 5
    s_mul_i32 s69, s71, 16640
    s_add_u32 s64, s64, s69
    s_add_u32 s64, s64, 96000
    v_lshl_add_u32 v244, v1, 4, s64
    s_waitcnt lgkmcnt(0)
    s_and_b32 s64, s63, 1
    s_lshl_b32 s64, s64, 4
    s_lshr_b32 s65, s65, s64
    s_lshl_b32 s65, s65, 16
    s_lshr_b32 s66, s66, s64
    s_lshl_b32 s66, s66, 16
    s_cmp_lt_u32 s39, 4
    v_mov_b32 v12, s65
    s_mov_b32 s69, 0x3fb8aa3b
    v_mul_f32 v13, s69, v12
    v_fma_f32 v15, v12, s69, -v13
    v_fmac_f32 v15, 0x32a57060, v12
    v_exp_f32 v13, v13
    v_mul_f32 v15, 0x3f317218, v15
    v_fma_f32 v13, v13, v15, v13
    v_cvt_pk_bf16_f32 v13, v13, v13
    v_lshlrev_b32 v15, 16, v13
    s_waitcnt vmcnt(0)
    v_lshlrev_b32 v20, 16, v4
    v_and_b32 v21, 0xffff0000, v4
    v_lshlrev_b32 v22, 16, v5
    v_and_b32 v23, 0xffff0000, v5
    v_lshlrev_b32 v24, 16, v6
    v_and_b32 v25, 0xffff0000, v6
    v_lshlrev_b32 v26, 16, v7
    v_and_b32 v27, 0xffff0000, v7
    v_lshlrev_b32 v28, 16, v8
    v_and_b32 v29, 0xffff0000, v8
    v_lshlrev_b32 v30, 16, v9
    v_and_b32 v31, 0xffff0000, v9
    v_mul_f32 v20, v15, v20
    v_mul_f32 v21, v15, v21
    v_mul_f32 v22, v15, v22
    v_mul_f32 v23, v15, v23
    v_mul_f32 v24, v15, v24
    v_mul_f32 v25, v15, v25
    v_mul_f32 v26, v15, v26
    v_mul_f32 v27, v15, v27
    v_mul_f32 v20, s69, v20
    v_mul_f32 v21, s69, v21
    v_mul_f32 v22, 0.15915494, v22
    v_mul_f32 v23, 0.15915494, v23
    v_mul_f32 v68, 0x41000000, v20
    v_mul_f32 v69, 0x41000000, v21
    v_mul_f32 v70, 0x41000000, v22
    v_mul_f32 v71, 0x41000000, v23
    v_exp_f32 v68, v68
    v_exp_f32 v69, v69
    v_fract_f32 v70, v70
    v_fract_f32 v71, v71
    v_cos_f32 v36, v70
    v_cos_f32 v37, v71
    v_sin_f32 v38, v70
    v_sin_f32 v39, v71
    v_mul_f32 v36, v68, v36
    v_mul_f32 v37, v69, v37
    v_mul_f32 v38, v68, v38
    v_mul_f32 v39, v69, v39
    v_exp_f32 v72, v20
    v_exp_f32 v73, v21
    v_fract_f32 v74, v22
    v_fract_f32 v75, v23
    v_cos_f32 v32, v74
    v_cos_f32 v33, v75
    v_sin_f32 v34, v74
    v_sin_f32 v35, v75
    v_mul_f32 v32, v72, v32
    v_mul_f32 v33, v73, v33
    v_mul_f32 v34, v72, v34
    v_mul_f32 v35, v73, v35
    v_mul_f32 v76, 0x43000000, v20
    v_mul_f32 v77, 0x43000000, v21
    v_mul_f32 v78, 0x43000000, v22
    v_mul_f32 v79, 0x43000000, v23
    v_exp_f32 v76, v76
    v_exp_f32 v77, v77
    v_fract_f32 v78, v78
    v_fract_f32 v79, v79
    v_cos_f32 v40, v78
    v_cos_f32 v41, v79
    v_sin_f32 v42, v78
    v_sin_f32 v43, v79
    v_mul_f32 v40, v76, v40
    v_mul_f32 v41, v77, v41
    v_mul_f32 v42, v76, v42
    v_mul_f32 v43, v77, v43
    v_pk_mul_f32 v[52:53], v[28:29], v[24:25]
    v_pk_mul_f32 v[44:45], v[32:33], v[32:33]
    v_pk_mul_f32 v[54:55], v[28:29], v[26:27]
    v_pk_mul_f32 v[46:47], v[32:33], v[34:35]
    v_pk_fma_f32 v[52:53], v[30:31], v[26:27], v[52:53] neg_lo:[1,0,0] neg_hi:[1,0,0]
    v_pk_fma_f32 v[44:45], v[34:35], v[34:35], v[44:45] neg_lo:[1,0,0] neg_hi:[1,0,0]
    v_pk_fma_f32 v[54:55], v[30:31], v[24:25], v[54:55]
    v_pk_fma_f32 v[46:47], v[34:35], v[32:33], v[46:47]
    v_pk_mul_f32 v[48:49], v[44:45], v[44:45]
    v_pk_mul_f32 v[50:51], v[44:45], v[46:47]
    v_pk_fma_f32 v[48:49], v[46:47], v[46:47], v[48:49] neg_lo:[1,0,0] neg_hi:[1,0,0]
    v_pk_fma_f32 v[50:51], v[46:47], v[44:45], v[50:51]
    v_mov_b32 v96, 0x3f80
    v_mov_b32 v97, 0x3f80
    v_pk_mul_f32 v[60:61], v[36:37], v[36:37]
    v_pk_mul_f32 v[62:63], v[36:37], v[38:39]
    v_cvt_pk_bf16_f32 v100, v36, v38
    v_pk_fma_f32 v[60:61], v[38:39], v[38:39], v[60:61] neg_lo:[1,0,0] neg_hi:[1,0,0]
    v_pk_fma_f32 v[62:63], v[38:39], v[36:37], v[62:63]
    v_cvt_pk_bf16_f32 v101, v37, v39
    v_pk_mul_f32 v[64:65], v[60:61], v[36:37]
    v_pk_mul_f32 v[66:67], v[60:61], v[38:39]
    v_cvt_pk_bf16_f32 v102, v60, v62
    v_pk_fma_f32 v[64:65], v[62:63], v[38:39], v[64:65] neg_lo:[1,0,0] neg_hi:[1,0,0]
    v_pk_fma_f32 v[66:67], v[62:63], v[36:37], v[66:67]
    v_cvt_pk_bf16_f32 v103, v61, v63
    v_pk_mul_f32 v[60:61], v[64:65], v[36:37]
    v_pk_mul_f32 v[62:63], v[64:65], v[38:39]
    v_cvt_pk_bf16_f32 v104, v64, v66
    v_pk_fma_f32 v[60:61], v[66:67], v[38:39], v[60:61] neg_lo:[1,0,0] neg_hi:[1,0,0]
    v_pk_fma_f32 v[62:63], v[66:67], v[36:37], v[62:63]
    v_cvt_pk_bf16_f32 v105, v65, v67
    v_pk_mul_f32 v[64:65], v[60:61], v[36:37]
    v_pk_mul_f32 v[66:67], v[60:61], v[38:39]
    v_cvt_pk_bf16_f32 v106, v60, v62
    v_pk_fma_f32 v[64:65], v[62:63], v[38:39], v[64:65] neg_lo:[1,0,0] neg_hi:[1,0,0]
    v_pk_fma_f32 v[66:67], v[62:63], v[36:37], v[66:67]
    v_cvt_pk_bf16_f32 v107, v61, v63
    v_pk_mul_f32 v[60:61], v[64:65], v[36:37]
    v_pk_mul_f32 v[62:63], v[64:65], v[38:39]
    v_cvt_pk_bf16_f32 v108, v64, v66
    v_pk_fma_f32 v[60:61], v[66:67], v[38:39], v[60:61] neg_lo:[1,0,0] neg_hi:[1,0,0]
    v_pk_fma_f32 v[62:63], v[66:67], v[36:37], v[62:63]
    v_cvt_pk_bf16_f32 v109, v65, v67
    v_pk_mul_f32 v[64:65], v[60:61], v[36:37]
    v_pk_mul_f32 v[66:67], v[60:61], v[38:39]
    v_cvt_pk_bf16_f32 v110, v60, v62
    v_pk_fma_f32 v[64:65], v[62:63], v[38:39], v[64:65] neg_lo:[1,0,0] neg_hi:[1,0,0]
    v_pk_fma_f32 v[66:67], v[62:63], v[36:37], v[66:67]
    v_cvt_pk_bf16_f32 v111, v61, v63
    v_pk_mul_f32 v[60:61], v[64:65], v[36:37]
    v_pk_mul_f32 v[62:63], v[64:65], v[38:39]
    v_cvt_pk_bf16_f32 v112, v64, v66
    v_pk_fma_f32 v[60:61], v[66:67], v[38:39], v[60:61] neg_lo:[1,0,0] neg_hi:[1,0,0]
    v_pk_fma_f32 v[62:63], v[66:67], v[36:37], v[62:63]
    v_cvt_pk_bf16_f32 v113, v65, v67
    v_pk_mul_f32 v[64:65], v[60:61], v[36:37]
    v_pk_mul_f32 v[66:67], v[60:61], v[38:39]
    v_cvt_pk_bf16_f32 v114, v60, v62
    v_pk_fma_f32 v[64:65], v[62:63], v[38:39], v[64:65] neg_lo:[1,0,0] neg_hi:[1,0,0]
    v_pk_fma_f32 v[66:67], v[62:63], v[36:37], v[66:67]
    v_cvt_pk_bf16_f32 v115, v61, v63
    v_pk_mul_f32 v[60:61], v[64:65], v[36:37]
    v_pk_mul_f32 v[62:63], v[64:65], v[38:39]
    v_cvt_pk_bf16_f32 v116, v64, v66
    v_pk_fma_f32 v[60:61], v[66:67], v[38:39], v[60:61] neg_lo:[1,0,0] neg_hi:[1,0,0]
    v_pk_fma_f32 v[62:63], v[66:67], v[36:37], v[62:63]
    v_cvt_pk_bf16_f32 v117, v65, v67
    v_pk_mul_f32 v[64:65], v[60:61], v[36:37]
    v_pk_mul_f32 v[66:67], v[60:61], v[38:39]
    v_cvt_pk_bf16_f32 v118, v60, v62
    v_pk_fma_f32 v[64:65], v[62:63], v[38:39], v[64:65] neg_lo:[1,0,0] neg_hi:[1,0,0]
    v_pk_fma_f32 v[66:67], v[62:63], v[36:37], v[66:67]
    v_cvt_pk_bf16_f32 v119, v61, v63
    v_pk_mul_f32 v[60:61], v[64:65], v[36:37]
    v_pk_mul_f32 v[62:63], v[64:65], v[38:39]
    v_cvt_pk_bf16_f32 v120, v64, v66
    v_pk_fma_f32 v[60:61], v[66:67], v[38:39], v[60:61] neg_lo:[1,0,0] neg_hi:[1,0,0]
    v_pk_fma_f32 v[62:63], v[66:67], v[36:37], v[62:63]
    v_cvt_pk_bf16_f32 v121, v65, v67
    v_pk_mul_f32 v[64:65], v[60:61], v[36:37]
    v_pk_mul_f32 v[66:67], v[60:61], v[38:39]
    v_cvt_pk_bf16_f32 v122, v60, v62
    v_pk_fma_f32 v[64:65], v[62:63], v[38:39], v[64:65] neg_lo:[1,0,0] neg_hi:[1,0,0]
    v_pk_fma_f32 v[66:67], v[62:63], v[36:37], v[66:67]
    v_cvt_pk_bf16_f32 v123, v61, v63
    v_pk_mul_f32 v[60:61], v[64:65], v[36:37]
    v_pk_mul_f32 v[62:63], v[64:65], v[38:39]
    v_cvt_pk_bf16_f32 v124, v64, v66
    v_pk_fma_f32 v[60:61], v[66:67], v[38:39], v[60:61] neg_lo:[1,0,0] neg_hi:[1,0,0]
    v_pk_fma_f32 v[62:63], v[66:67], v[36:37], v[62:63]
    v_cvt_pk_bf16_f32 v125, v65, v67
    v_pk_mul_f32 v[64:65], v[60:61], v[36:37]
    v_pk_mul_f32 v[66:67], v[60:61], v[38:39]
    v_cvt_pk_bf16_f32 v126, v60, v62
    v_pk_fma_f32 v[64:65], v[62:63], v[38:39], v[64:65] neg_lo:[1,0,0] neg_hi:[1,0,0]
    v_pk_fma_f32 v[66:67], v[62:63], v[36:37], v[66:67]
    v_cvt_pk_bf16_f32 v127, v61, v63
    v_cvt_pk_bf16_f32 v128, v64, v66
    v_cvt_pk_bf16_f32 v129, v65, v67
    v_pk_mul_f32 v[60:61], v[52:53], v[32:33]
    v_pk_mul_f32 v[62:63], v[52:53], v[34:35]
    v_cvt_pk_bf16_f32 v130, v52, -v54
    v_pk_fma_f32 v[60:61], v[54:55], v[34:35], v[60:61] neg_lo:[1,0,0] neg_hi:[1,0,0]
    v_pk_fma_f32 v[62:63], v[54:55], v[32:33], v[62:63]
    v_cvt_pk_bf16_f32 v131, v53, -v55
    v_pk_mul_f32 v[64:65], v[60:61], v[32:33]
    v_pk_mul_f32 v[66:67], v[60:61], v[34:35]
    v_cvt_pk_bf16_f32 v132, v60, -v62
    v_pk_fma_f32 v[64:65], v[62:63], v[34:35], v[64:65] neg_lo:[1,0,0] neg_hi:[1,0,0]
    v_pk_fma_f32 v[66:67], v[62:63], v[32:33], v[66:67]
    v_cvt_pk_bf16_f32 v133, v61, -v63
    v_pk_mul_f32 v[60:61], v[64:65], v[32:33]
    v_pk_mul_f32 v[62:63], v[64:65], v[34:35]
    v_cvt_pk_bf16_f32 v134, v64, -v66
    v_pk_fma_f32 v[60:61], v[66:67], v[34:35], v[60:61] neg_lo:[1,0,0] neg_hi:[1,0,0]
    v_pk_fma_f32 v[62:63], v[66:67], v[32:33], v[62:63]
    v_cvt_pk_bf16_f32 v135, v65, -v67
    v_pk_mul_f32 v[64:65], v[60:61], v[32:33]
    v_pk_mul_f32 v[66:67], v[60:61], v[34:35]
    v_cvt_pk_bf16_f32 v136, v60, -v62
    v_pk_fma_f32 v[64:65], v[62:63], v[34:35], v[64:65] neg_lo:[1,0,0] neg_hi:[1,0,0]
    v_pk_fma_f32 v[66:67], v[62:63], v[32:33], v[66:67]
    v_cvt_pk_bf16_f32 v137, v61, -v63
    v_pk_mul_f32 v[60:61], v[64:65], v[32:33]
    v_pk_mul_f32 v[62:63], v[64:65], v[34:35]
    v_cvt_pk_bf16_f32 v138, v64, -v66
    s_cbranch_scc1 L_kb6
    s_barrier
L_kb6:
    v_pk_fma_f32 v[60:61], v[66:67], v[34:35], v[60:61] neg_lo:[1,0,0] neg_hi:[1,0,0]
    v_pk_fma_f32 v[62:63], v[66:67], v[32:33], v[62:63]
    v_cvt_pk_bf16_f32 v139, v65, -v67
    v_pk_mul_f32 v[64:65], v[60:61], v[32:33]
    v_pk_mul_f32 v[66:67], v[60:61], v[34:35]
    v_cvt_pk_bf16_f32 v140, v60, -v62
    v_pk_fma_f32 v[64:65], v[62:63], v[34:35], v[64:65] neg_lo:[1,0,0] neg_hi:[1,0,0]
    v_pk_fma_f32 v[66:67], v[62:63], v[32:33], v[66:67]
    v_cvt_pk_bf16_f32 v141, v61, -v63
    v_pk_mul_f32 v[60:61], v[64:65], v[32:33]
    v_pk_mul_f32 v[62:63], v[64:65], v[34:35]
    v_cvt_pk_bf16_f32 v142, v64, -v66
    v_pk_fma_f32 v[60:61], v[66:67], v[34:35], v[60:61] neg_lo:[1,0,0] neg_hi:[1,0,0]
    v_pk_fma_f32 v[62:63], v[66:67], v[32:33], v[62:63]
    v_cvt_pk_bf16_f32 v143, v65, -v67
    v_cvt_pk_bf16_f32 v144, v60, -v62
    v_cvt_pk_bf16_f32 v145, v61, -v63
    v_pk_mul_f32 v[56:57], v[52:53], v[40:41]
    v_pk_mul_f32 v[58:59], v[52:53], v[42:43]
    v_pk_fma_f32 v[56:57], v[54:55], v[42:43], v[56:57] neg_lo:[1,0,0] neg_hi:[1,0,0]
    v_pk_fma_f32 v[58:59], v[54:55], v[40:41], v[58:59]
    v_pk_mul_f32 v[60:61], v[56:57], v[32:33]
    v_pk_mul_f32 v[62:63], v[56:57], v[34:35]
    v_cvt_pk_bf16_f32 v146, v56, -v58
    v_pk_fma_f32 v[60:61], v[58:59], v[34:35], v[60:61] neg_lo:[1,0,0] neg_hi:[1,0,0]
    v_pk_fma_f32 v[62:63], v[58:59], v[32:33], v[62:63]
    v_cvt_pk_bf16_f32 v147, v57, -v59
    v_pk_mul_f32 v[64:65], v[60:61], v[32:33]
    v_pk_mul_f32 v[66:67], v[60:61], v[34:35]
    v_cvt_pk_bf16_f32 v148, v60, -v62
    v_pk_fma_f32 v[64:65], v[62:63], v[34:35], v[64:65] neg_lo:[1,0,0] neg_hi:[1,0,0]
    v_pk_fma_f32 v[66:67], v[62:63], v[32:33], v[66:67]
    v_cvt_pk_bf16_f32 v149, v61, -v63
    v_pk_mul_f32 v[60:61], v[64:65], v[32:33]
    v_pk_mul_f32 v[62:63], v[64:65], v[34:35]
    v_cvt_pk_bf16_f32 v150, v64, -v66
    v_pk_fma_f32 v[60:61], v[66:67], v[34:35], v[60:61] neg_lo:[1,0,0] neg_hi:[1,0,0]
    v_pk_fma_f32 v[62:63], v[66:67], v[32:33], v[62:63]
    v_cvt_pk_bf16_f32 v151, v65, -v67
    v_pk_mul_f32 v[64:65], v[60:61], v[32:33]
    v_pk_mul_f32 v[66:67], v[60:61], v[34:35]
    v_cvt_pk_bf16_f32 v152, v60, -v62
    v_pk_fma_f32 v[64:65], v[62:63], v[34:35], v[64:65] neg_lo:[1,0,0] neg_hi:[1,0,0]
    v_pk_fma_f32 v[66:67], v[62:63], v[32:33], v[66:67]
    v_cvt_pk_bf16_f32 v153, v61, -v63
    v_pk_mul_f32 v[60:61], v[64:65], v[32:33]
    v_pk_mul_f32 v[62:63], v[64:65], v[34:35]
    v_cvt_pk_bf16_f32 v154, v64, -v66
    v_pk_fma_f32 v[60:61], v[66:67], v[34:35], v[60:61] neg_lo:[1,0,0] neg_hi:[1,0,0]
    v_pk_fma_f32 v[62:63], v[66:67], v[32:33], v[62:63]
    v_cvt_pk_bf16_f32 v155, v65, -v67
    v_pk_mul_f32 v[64:65], v[60:61], v[32:33]
    v_pk_mul_f32 v[66:67], v[60:61], v[34:35]
    v_cvt_pk_bf16_f32 v156, v60, -v62
    v_pk_fma_f32 v[64:65], v[62:63], v[34:35], v[64:65] neg_lo:[1,0,0] neg_hi:[1,0,0]
    v_pk_fma_f32 v[66:67], v[62:63], v[32:33], v[66:67]
    v_cvt_pk_bf16_f32 v157, v61, -v63
    v_pk_mul_f32 v[60:61], v[64:65], v[32:33]
    v_pk_mul_f32 v[62:63], v[64:65], v[34:35]
    v_cvt_pk_bf16_f32 v158, v64, -v66
    v_pk_fma_f32 v[60:61], v[66:67], v[34:35], v[60:61] neg_lo:[1,0,0] neg_hi:[1,0,0]
    v_pk_fma_f32 v[62:63], v[66:67], v[32:33], v[62:63]
    v_cvt_pk_bf16_f32 v159, v65, -v67
    v_cvt_pk_bf16_f32 v160, v60, -v62
    v_cvt_pk_bf16_f32 v161, v61, -v63
    v_pk_mul_f32 v[52:53], v[56:57], v[40:41]
    v_pk_mul_f32 v[54:55], v[56:57], v[42:43]
    v_pk_fma_f32 v[52:53], v[58:59], v[42:43], v[52:53] neg_lo:[1,0,0] neg_hi:[1,0,0]
    v_pk_fma_f32 v[54:55], v[58:59], v[40:41], v[54:55]
    v_pk_mul_f32 v[60:61], v[52:53], v[44:45]
    v_pk_mul_f32 v[62:63], v[52:53], v[46:47]
    v_cvt_pk_bf16_f32 v162, v52, -v54
    v_pk_fma_f32 v[60:61], v[54:55], v[46:47], v[60:61] neg_lo:[1,0,0] neg_hi:[1,0,0]
    v_pk_fma_f32 v[62:63], v[54:55], v[44:45], v[62:63]
    v_cvt_pk_bf16_f32 v163, v53, -v55
    v_pk_mul_f32 v[64:65], v[60:61], v[44:45]
    v_pk_mul_f32 v[66:67], v[60:61], v[46:47]
    v_cvt_pk_bf16_f32 v164, v60, -v62
    v_pk_fma_f32 v[64:65], v[62:63], v[46:47], v[64:65] neg_lo:[1,0,0] neg_hi:[1,0,0]
    v_pk_fma_f32 v[66:67], v[62:63], v[44:45], v[66:67]
    v_cvt_pk_bf16_f32 v165, v61, -v63
    v_pk_mul_f32 v[60:61], v[64:65], v[44:45]
    v_pk_mul_f32 v[62:63], v[64:65], v[46:47]
    v_cvt_pk_bf16_f32 v166, v64, -v66
    v_pk_fma_f32 v[60:61], v[66:67], v[46:47], v[60:61] neg_lo:[1,0,0] neg_hi:[1,0,0]
    v_pk_fma_f32 v[62:63], v[66:67], v[44:45], v[62:63]
    v_cvt_pk_bf16_f32 v167, v65, -v67
    v_cvt_pk_bf16_f32 v168, v60, -v62
    v_cvt_pk_bf16_f32 v169, v61, -v63
    v_pk_mul_f32 v[56:57], v[52:53], v[40:41]
    v_pk_mul_f32 v[58:59], v[52:53], v[42:43]
    v_pk_fma_f32 v[56:57], v[54:55], v[42:43], v[56:57] neg_lo:[1,0,0] neg_hi:[1,0,0]
    v_pk_fma_f32 v[58:59], v[54:55], v[40:41], v[58:59]
    v_pk_mul_f32 v[60:61], v[56:57], v[44:45]
    v_pk_mul_f32 v[62:63], v[56:57], v[46:47]
    v_cvt_pk_bf16_f32 v170, v56, -v58
    v_pk_fma_f32 v[60:61], v[58:59], v[46:47], v[60:61] neg_lo:[1,0,0] neg_hi:[1,0,0]
    v_pk_fma_f32 v[62:63], v[58:59], v[44:45], v[62:63]
    v_cvt_pk_bf16_f32 v171, v57, -v59
    v_pk_mul_f32 v[64:65], v[60:61], v[44:45]
    v_pk_mul_f32 v[66:67], v[60:61], v[46:47]
    v_cvt_pk_bf16_f32 v172, v60, -v62
    v_pk_fma_f32 v[64:65], v[62:63], v[46:47], v[64:65] neg_lo:[1,0,0] neg_hi:[1,0,0]
    v_pk_fma_f32 v[66:67], v[62:63], v[44:45], v[66:67]
    v_cvt_pk_bf16_f32 v173, v61, -v63
    v_pk_mul_f32 v[60:61], v[64:65], v[44:45]
    v_pk_mul_f32 v[62:63], v[64:65], v[46:47]
    v_cvt_pk_bf16_f32 v174, v64, -v66
    v_pk_fma_f32 v[60:61], v[66:67], v[46:47], v[60:61] neg_lo:[1,0,0] neg_hi:[1,0,0]
    v_pk_fma_f32 v[62:63], v[66:67], v[44:45], v[62:63]
    v_cvt_pk_bf16_f32 v175, v65, -v67
    v_cvt_pk_bf16_f32 v176, v60, -v62
    v_cvt_pk_bf16_f32 v177, v61, -v63
    v_pk_mul_f32 v[52:53], v[56:57], v[40:41]
    v_pk_mul_f32 v[54:55], v[56:57], v[42:43]
    v_pk_fma_f32 v[52:53], v[58:59], v[42:43], v[52:53] neg_lo:[1,0,0] neg_hi:[1,0,0]
    v_pk_fma_f32 v[54:55], v[58:59], v[40:41], v[54:55]
    v_pk_mul_f32 v[60:61], v[52:53], v[48:49]
    v_pk_mul_f32 v[62:63], v[52:53], v[50:51]
    v_cvt_pk_bf16_f32 v178, v52, -v54
    v_pk_fma_f32 v[60:61], v[54:55], v[50:51], v[60:61] neg_lo:[1,0,0] neg_hi:[1,0,0]
    v_pk_fma_f32 v[62:63], v[54:55], v[48:49], v[62:63]
    v_cvt_pk_bf16_f32 v179, v53, -v55
    v_cvt_pk_bf16_f32 v180, v60, -v62
    v_cvt_pk_bf16_f32 v181, v61, -v63
    v_pk_mul_f32 v[56:57], v[52:53], v[40:41]
    v_pk_mul_f32 v[58:59], v[52:53], v[42:43]
    v_pk_fma_f32 v[56:57], v[54:55], v[42:43], v[56:57] neg_lo:[1,0,0] neg_hi:[1,0,0]
    v_pk_fma_f32 v[58:59], v[54:55], v[40:41], v[58:59]
    v_pk_mul_f32 v[60:61], v[56:57], v[48:49]
    v_pk_mul_f32 v[62:63], v[56:57], v[50:51]
    v_cvt_pk_bf16_f32 v182, v56, -v58
    v_pk_fma_f32 v[60:61], v[58:59], v[50:51], v[60:61] neg_lo:[1,0,0] neg_hi:[1,0,0]
    v_pk_fma_f32 v[62:63], v[58:59], v[48:49], v[62:63]
    v_cvt_pk_bf16_f32 v183, v57, -v59
    v_cvt_pk_bf16_f32 v184, v60, -v62
    v_cvt_pk_bf16_f32 v185, v61, -v63
    v_pk_mul_f32 v[52:53], v[56:57], v[40:41]
    v_pk_mul_f32 v[54:55], v[56:57], v[42:43]
    v_pk_fma_f32 v[52:53], v[58:59], v[42:43], v[52:53] neg_lo:[1,0,0] neg_hi:[1,0,0]
    v_pk_fma_f32 v[54:55], v[58:59], v[40:41], v[54:55]
    v_pk_mul_f32 v[60:61], v[52:53], v[48:49]
    v_pk_mul_f32 v[62:63], v[52:53], v[50:51]
    v_cvt_pk_bf16_f32 v186, v52, -v54
    v_pk_fma_f32 v[60:61], v[54:55], v[50:51], v[60:61] neg_lo:[1,0,0] neg_hi:[1,0,0]
    v_pk_fma_f32 v[62:63], v[54:55], v[48:49], v[62:63]
    v_cvt_pk_bf16_f32 v187, v53, -v55
    v_cvt_pk_bf16_f32 v188, v60, -v62
    v_cvt_pk_bf16_f32 v189, v61, -v63
    v_pk_mul_f32 v[56:57], v[52:53], v[40:41]
    v_pk_mul_f32 v[58:59], v[52:53], v[42:43]
    v_pk_fma_f32 v[56:57], v[54:55], v[42:43], v[56:57] neg_lo:[1,0,0] neg_hi:[1,0,0]
    v_pk_fma_f32 v[58:59], v[54:55], v[40:41], v[58:59]
    v_pk_mul_f32 v[60:61], v[56:57], v[48:49]
    v_pk_mul_f32 v[62:63], v[56:57], v[50:51]
    v_cvt_pk_bf16_f32 v190, v56, -v58
    v_pk_fma_f32 v[60:61], v[58:59], v[50:51], v[60:61] neg_lo:[1,0,0] neg_hi:[1,0,0]
    v_pk_fma_f32 v[62:63], v[58:59], v[48:49], v[62:63]
    v_cvt_pk_bf16_f32 v191, v57, -v59
    v_cvt_pk_bf16_f32 v192, v60, -v62
    v_cvt_pk_bf16_f32 v193, v61, -v63
    v_pk_mul_f32 v[52:53], v[56:57], v[40:41]
    v_pk_mul_f32 v[54:55], v[56:57], v[42:43]
    v_pk_fma_f32 v[52:53], v[58:59], v[42:43], v[52:53] neg_lo:[1,0,0] neg_hi:[1,0,0]
    v_pk_fma_f32 v[54:55], v[58:59], v[40:41], v[54:55]
    v_pk_mul_f32 v[56:57], v[52:53], v[40:41]
    v_pk_mul_f32 v[58:59], v[52:53], v[42:43]
    v_cvt_pk_bf16_f32 v194, v52, -v54
    v_pk_fma_f32 v[56:57], v[54:55], v[42:43], v[56:57] neg_lo:[1,0,0] neg_hi:[1,0,0]
    v_pk_fma_f32 v[58:59], v[54:55], v[40:41], v[58:59]
    v_cvt_pk_bf16_f32 v195, v53, -v55
    v_pk_mul_f32 v[52:53], v[56:57], v[40:41]
    v_pk_mul_f32 v[54:55], v[56:57], v[42:43]
    v_cvt_pk_bf16_f32 v196, v56, -v58
    v_pk_fma_f32 v[52:53], v[58:59], v[42:43], v[52:53] neg_lo:[1,0,0] neg_hi:[1,0,0]
    v_pk_fma_f32 v[54:55], v[58:59], v[40:41], v[54:55]
    v_cvt_pk_bf16_f32 v197, v57, -v59
    v_pk_mul_f32 v[56:57], v[52:53], v[40:41]
    v_pk_mul_f32 v[58:59], v[52:53], v[42:43]
    v_cvt_pk_bf16_f32 v198, v52, -v54
    v_pk_fma_f32 v[56:57], v[54:55], v[42:43], v[56:57] neg_lo:[1,0,0] neg_hi:[1,0,0]
    v_pk_fma_f32 v[58:59], v[54:55], v[40:41], v[58:59]
    v_cvt_pk_bf16_f32 v199, v53, -v55
    v_pk_mul_f32 v[52:53], v[56:57], v[40:41]
    v_pk_mul_f32 v[54:55], v[56:57], v[42:43]
    v_cvt_pk_bf16_f32 v200, v56, -v58
    v_pk_fma_f32 v[52:53], v[58:59], v[42:43], v[52:53] neg_lo:[1,0,0] neg_hi:[1,0,0]
    v_pk_fma_f32 v[54:55], v[58:59], v[40:41], v[54:55]
    v_cvt_pk_bf16_f32 v201, v57, -v59
    v_pk_mul_f32 v[56:57], v[52:53], v[40:41]
    v_pk_mul_f32 v[58:59], v[52:53], v[42:43]
    v_cvt_pk_bf16_f32 v202, v52, -v54
    v_pk_fma_f32 v[56:57], v[54:55], v[42:43], v[56:57] neg_lo:[1,0,0] neg_hi:[1,0,0]
    v_pk_fma_f32 v[58:59], v[54:55], v[40:41], v[58:59]
    v_cvt_pk_bf16_f32 v203, v53, -v55
    v_pk_mul_f32 v[52:53], v[56:57], v[40:41]
    v_pk_mul_f32 v[54:55], v[56:57], v[42:43]
    v_cvt_pk_bf16_f32 v204, v56, -v58
    v_pk_fma_f32 v[52:53], v[58:59], v[42:43], v[52:53] neg_lo:[1,0,0] neg_hi:[1,0,0]
    v_pk_fma_f32 v[54:55], v[58:59], v[40:41], v[54:55]
    v_cvt_pk_bf16_f32 v205, v57, -v59
    v_pk_mul_f32 v[56:57], v[52:53], v[40:41]
    v_pk_mul_f32 v[58:59], v[52:53], v[42:43]
    v_cvt_pk_bf16_f32 v206, v52, -v54
    v_pk_fma_f32 v[56:57], v[54:55], v[42:43], v[56:57] neg_lo:[1,0,0] neg_hi:[1,0,0]
    v_pk_fma_f32 v[58:59], v[54:55], v[40:41], v[58:59]
    v_cvt_pk_bf16_f32 v207, v53, -v55
    v_pk_mul_f32 v[52:53], v[56:57], v[40:41]
    v_pk_mul_f32 v[54:55], v[56:57], v[42:43]
    v_cvt_pk_bf16_f32 v208, v56, -v58
    v_pk_fma_f32 v[52:53], v[58:59], v[42:43], v[52:53] neg_lo:[1,0,0] neg_hi:[1,0,0]
    v_pk_fma_f32 v[54:55], v[58:59], v[40:41], v[54:55]
    v_cvt_pk_bf16_f32 v209, v57, -v59
    v_cvt_pk_bf16_f32 v210, v52, -v54
    v_cvt_pk_bf16_f32 v211, v53, -v55
    v_and_b32 v12, s66, v236
    s_cbranch_scc1 L_kb7
    s_barrier
L_kb7:
    s_cbranch_scc1 L_kb8
    s_barrier
L_kb8:
    s_cbranch_scc1 L_kb9
    s_barrier
L_kb9:
    s_cbranch_scc1 L_kb10
    s_barrier
L_kb10:
    s_cbranch_scc1 L_kb11
    s_barrier
L_kb11:
    s_cbranch_scc1 L_kb12
    s_barrier
L_kb12:
    s_cbranch_scc1 L_kb13
    s_barrier
L_kb13:
    s_cbranch_scc1 L_kb14
    s_barrier
L_kb14:
    s_cbranch_scc1 L_kb15
    s_barrier
L_kb15:
    s_mov_b32 s44, s4
    s_and_b32 s45, s5, 0xffff
    s_mov_b32 s46, 2621440
    s_mov_b32 s47, 0x20000
    s_mov_b32 s48, s30
    s_and_b32 s49, s31, 0xffff
    s_mov_b32 s50, 1280
    s_mov_b32 s51, 0x20000
    v_and_b32 v20, 3, v1
    v_lshrrev_b32 v21, 2, v1
    v_mul_u32_u24 v21, 1280, v21
    v_lshlrev_b32 v22, 3, v20
    v_lshlrev_b32 v20, 4, v20
    v_add_u32 v23, v21, v22
    v_add_u32 v21, v21, v20
    s_lshl_b32 s69, s56, 2
    s_add_u32 s69, s69, s3
    s_sub_u32 s69, s69, 4
    s_mul_i32 s69, s69, 20480
    s_mul_i32 s70, s57, 160
    s_add_u32 s69, s69, s70
    buffer_load_dwordx4 v[212:215], v21, s[44:47], s69 offen
    buffer_load_dwordx4 v[216:219], v21, s[44:47], s69 offen offset:64
    buffer_load_dwordx2 v[238:239], v23, s[44:47], s69 offen offset:128
    buffer_load_dwordx4 v[248:251], v20, s[48:51], s70 offen
    buffer_load_dwordx4 v[252:255], v20, s[48:51], s70 offen offset:64
    buffer_load_dwordx2 v[246:247], v22, s[48:51], s70 offen offset:128
    ds_write_b64 v10, v[96:97] offset:0
    ds_write_b64 v10, v[100:101] offset:544
    ds_write_b64 v10, v[102:103] offset:1088
    ds_write_b64 v10, v[104:105] offset:1632
    ds_write_b64 v10, v[106:107] offset:2176
    ds_write_b64 v10, v[108:109] offset:2720
    ds_write_b64 v10, v[110:111] offset:3264
    ds_write_b64 v10, v[112:113] offset:3808
    ds_write_b64 v10, v[114:115] offset:4352
    ds_write_b64 v10, v[116:117] offset:4896
    ds_write_b64 v10, v[118:119] offset:5440
    ds_write_b64 v10, v[120:121] offset:5984
    ds_write_b64 v10, v[122:123] offset:6528
    ds_write_b64 v10, v[124:125] offset:7072
    ds_write_b64 v10, v[126:127] offset:7616
    ds_write_b64 v10, v[128:129] offset:8160
    ds_read_b128 v[20:23], v11 offset:0
    ds_read_b128 v[24:27], v11 offset:64
    ds_read_b128 v[28:31], v11 offset:128
    ds_read_b128 v[32:35], v11 offset:192
    ds_read_b128 v[36:39], v11 offset:256
    ds_read_b128 v[40:43], v11 offset:320
    ds_read_b128 v[44:47], v11 offset:384
    ds_read_b128 v[48:51], v11 offset:448
    ds_write_b64 v10, v[130:131] offset:0
    ds_write_b64 v10, v[132:133] offset:544
    ds_write_b64 v10, v[134:135] offset:1088
    ds_write_b64 v10, v[136:137] offset:1632
    ds_write_b64 v10, v[138:139] offset:2176
    ds_write_b64 v10, v[140:141] offset:2720
    ds_write_b64 v10, v[142:143] offset:3264
    ds_write_b64 v10, v[144:145] offset:3808
    ds_write_b64 v10, v[146:147] offset:4352
    ds_write_b64 v10, v[148:149] offset:4896
    ds_write_b64 v10, v[150:151] offset:5440
    ds_write_b64 v10, v[152:153] offset:5984
    ds_write_b64 v10, v[154:155] offset:6528
    ds_write_b64 v10, v[156:157] offset:7072
    ds_write_b64 v10, v[158:159] offset:7616
    ds_write_b64 v10, v[160:161] offset:8160
    v_mov_b32 v98, 16
    s_mov_b32 s77, 0
L_lw5:
    ds_read_b32 v99, v98
    s_waitcnt lgkmcnt(0)
    v_cmp_le_u32 vcc, 11, v99
    s_nop 0
    s_cmp_eq_u64 vcc, -1
    s_cbranch_scc1 L_lx5
    s_add_u32 s77, s77, 1
    s_cmp_ge_u32 s77, 160000
    s_cbranch_scc1 L_lx5
    s_sleep 1
    s_branch L_lw5
L_lx5:
    s_setprio 1
    ds_read_b128 v[52:55], v11 offset:0
    ds_read_b128 v[56:59], v11 offset:64
    ds_read_b128 v[60:63], v11 offset:128
    ds_read_b128 v[64:67], v11 offset:192
    ds_read_b128 v[68:71], v11 offset:256
    ds_read_b128 v[72:75], v11 offset:320
    ds_read_b128 v[76:79], v11 offset:384
    ds_read_b128 v[80:83], v11 offset:448
    ds_write_b64 v10, v[162:163] offset:0
    ds_write_b64 v10, v[164:165] offset:544
    ds_write_b64 v10, v[166:167] offset:1088
    ds_write_b64 v10, v[168:169] offset:1632
    ds_write_b64 v10, v[170:171] offset:2176
    ds_write_b64 v10, v[172:173] offset:2720
    ds_write_b64 v10, v[174:175] offset:3264
    ds_write_b64 v10, v[176:177] offset:3808
    s_waitcnt lgkmcnt(8)
    v_mfma_f32_16x16x32_bf16 v[84:87], v[52:55], v[20:23], 0
    v_mfma_f32_16x16x32_bf16 v[84:87], v[56:59], v[24:27], v[84:87]
    v_mfma_f32_16x16x32_bf16 v[84:87], v[60:63], v[28:31], v[84:87]
    v_mfma_f32_16x16x32_bf16 v[84:87], v[64:67], v[32:35], v[84:87]
    v_mfma_f32_16x16x32_bf16 v[84:87], v[68:71], v[36:39], v[84:87]
    v_mfma_f32_16x16x32_bf16 v[84:87], v[72:75], v[40:43], v[84:87]
    v_mfma_f32_16x16x32_bf16 v[84:87], v[76:79], v[44:47], v[84:87]
    v_mfma_f32_16x16x32_bf16 v[84:87], v[80:83], v[48:51], v[84:87]
    ds_write_b64 v10, v[178:179] offset:4352
    ds_write_b64 v10, v[180:181] offset:4896
    ds_write_b64 v10, v[182:183] offset:5440
    ds_write_b64 v10, v[184:185] offset:5984
    ds_write_b64 v10, v[186:187] offset:6528
    ds_write_b64 v10, v[188:189] offset:7072
    ds_write_b64 v10, v[190:191] offset:7616
    ds_write_b64 v10, v[192:193] offset:8160
    ds_read_b128 v[52:55], v11 offset:0
    ds_read_b128 v[56:59], v11 offset:64
    ds_read_b128 v[60:63], v11 offset:128
    ds_read_b128 v[64:67], v11 offset:192
    ds_read_b128 v[68:71], v11 offset:256
    ds_read_b128 v[72:75], v11 offset:320
    ds_read_b128 v[76:79], v11 offset:384
    ds_read_b128 v[80:83], v11 offset:448
    ds_write_b64 v10, v[194:195] offset:0
    ds_write_b64 v10, v[196:197] offset:544
    ds_write_b64 v10, v[198:199] offset:1088
    ds_write_b64 v10, v[200:201] offset:1632
    ds_write_b64 v10, v[202:203] offset:2176
    ds_write_b64 v10, v[204:205] offset:2720
    ds_write_b64 v10, v[206:207] offset:3264
    ds_write_b64 v10, v[208:209] offset:3808
    s_waitcnt lgkmcnt(8)
    v_mfma_f32_16x16x32_bf16 v[88:91], v[52:55], v[20:23], 0
    v_mfma_f32_16x16x32_bf16 v[88:91], v[56:59], v[24:27], v[88:91]
    v_mfma_f32_16x16x32_bf16 v[88:91], v[60:63], v[28:31], v[88:91]
    v_mfma_f32_16x16x32_bf16 v[88:91], v[64:67], v[32:35], v[88:91]
    v_mfma_f32_16x16x32_bf16 v[88:91], v[68:71], v[36:39], v[88:91]
    v_mfma_f32_16x16x32_bf16 v[88:91], v[72:75], v[40:43], v[88:91]
    v_mfma_f32_16x16x32_bf16 v[88:91], v[76:79], v[44:47], v[88:91]
    v_mfma_f32_16x16x32_bf16 v[88:91], v[80:83], v[48:51], v[88:91]
    ds_write_b64 v10, v[210:211] offset:4352
    ds_read_b128 v[52:55], v11 offset:0
    ds_read_b128 v[56:59], v11 offset:64
    ds_read_b128 v[60:63], v11 offset:128
    ds_read_b128 v[64:67], v11 offset:192
    ds_read_b128 v[68:71], v11 offset:256
    ds_read_b128 v[72:75], v11 offset:320
    ds_read_b128 v[76:79], v11 offset:384
    ds_read_b128 v[80:83], v11 offset:448
    v_add_f32 v84, v84, v12
    v_cvt_pk_bf16_f32 v4, v84, v85
    v_cvt_pk_bf16_f32 v5, v86, v87
    v_cvt_pk_bf16_f32 v6, v88, v89
    v_cvt_pk_bf16_f32 v7, v90, v91
    ds_write_b64 v220, v[4:5]
    ds_write_b32 v221, v6 offset:512
    ds_write_b32 v222, v7 offset:512
    s_waitcnt lgkmcnt(3)
    v_mfma_f32_16x16x32_bf16 v[92:95], v[20:23], v[52:55], 0
    v_mfma_f32_16x16x32_bf16 v[92:95], v[24:27], v[56:59], v[92:95]
    v_mfma_f32_16x16x32_bf16 v[92:95], v[28:31], v[60:63], v[92:95]
    v_mfma_f32_16x16x32_bf16 v[92:95], v[32:35], v[64:67], v[92:95]
    v_mfma_f32_16x16x32_bf16 v[92:95], v[36:39], v[68:71], v[92:95]
    v_mfma_f32_16x16x32_bf16 v[92:95], v[40:43], v[72:75], v[92:95]
    v_mfma_f32_16x16x32_bf16 v[92:95], v[44:47], v[76:79], v[92:95]
    v_mfma_f32_16x16x32_bf16 v[92:95], v[48:51], v[80:83], v[92:95]
    ds_read_u16 v139, v227 offset:640
    ds_read_u16 v159, v228 offset:640
    ds_read_u16 v179, v229 offset:640
    ds_read_u16 v140, v227 offset:576
    ds_read_u16 v160, v228 offset:576
    ds_read_u16 v180, v229 offset:576
    ds_read_u16 v141, v227 offset:512
    ds_read_u16 v161, v228 offset:512
    ds_read_u16 v181, v229 offset:512
    ds_read_u16 v142, v230 offset:384
    ds_read_u16 v162, v231 offset:384
    ds_read_u16 v182, v232 offset:384
    ds_read_u16 v143, v230 offset:256
    ds_read_u16 v163, v231 offset:256
    ds_read_u16 v183, v232 offset:256
    ds_read_u16 v144, v233 offset:256
    ds_read_u16 v164, v234 offset:256
    ds_read_u16 v184, v235 offset:256
    ds_read_u16 v145, v233 offset:0
    ds_read_u16 v165, v234 offset:0
    ds_read_u16 v185, v235 offset:0
    v_cvt_pk_bf16_f32 v8, v92, v93
    v_cvt_pk_bf16_f32 v9, v94, v95
    ds_write_b64 v223, v[8:9] offset:1024
    ds_read_u16 v130, v224 offset:992
    ds_read_u16 v150, v225 offset:992
    ds_read_u16 v170, v226 offset:992
    ds_read_u16 v131, v224 offset:960
    ds_read_u16 v151, v225 offset:960
    ds_read_u16 v171, v226 offset:960
    ds_read_u16 v132, v224 offset:928
    ds_read_u16 v152, v225 offset:928
    ds_read_u16 v172, v226 offset:928
    ds_read_u16 v133, v224 offset:896
    ds_read_u16 v153, v225 offset:896
    ds_read_u16 v173, v226 offset:896
    ds_read_u16 v134, v224 offset:864
    ds_read_u16 v154, v225 offset:864
    ds_read_u16 v174, v226 offset:864
    ds_read_u16 v135, v224 offset:832
    ds_read_u16 v155, v225 offset:832
    ds_read_u16 v175, v226 offset:832
    ds_read_u16 v136, v224 offset:800
    ds_read_u16 v156, v225 offset:800
    ds_read_u16 v176, v226 offset:800
    ds_read_u16 v137, v224 offset:768
    ds_read_u16 v157, v225 offset:768
    ds_read_u16 v177, v226 offset:768
    ds_read_u16 v138, v227 offset:704
    ds_read_u16 v158, v228 offset:704
    ds_read_u16 v178, v229 offset:704
    v_and_b32 v146, 0xffff, v4
    v_and_b32 v146, v236, v146
    v_mov_b32 v186, 0
    s_lshl_b32 s68, s62, 2
    s_add_u32 s68, s68, 112
    v_mov_b32 v20, s68
    v_mov_b32 v21, 1
    s_mov_b64 exec, 1
    ds_write_b32 v20, v21
    s_mov_b64 exec, -1
    s_waitcnt lgkmcnt(0)
    v_lshl_or_b32 v170, v170, 16, v150
    v_lshl_or_b32 v130, v150, 16, v130
    v_lshl_or_b32 v171, v171, 16, v151
    v_lshl_or_b32 v131, v151, 16, v131
    v_lshl_or_b32 v172, v172, 16, v152
    v_lshl_or_b32 v132, v152, 16, v132
    v_lshl_or_b32 v173, v173, 16, v153
    v_lshl_or_b32 v133, v153, 16, v133
    v_lshl_or_b32 v174, v174, 16, v154
    v_lshl_or_b32 v134, v154, 16, v134
    v_lshl_or_b32 v175, v175, 16, v155
    v_lshl_or_b32 v135, v155, 16, v135
    v_lshl_or_b32 v176, v176, 16, v156
    v_lshl_or_b32 v136, v156, 16, v136
    v_lshl_or_b32 v177, v177, 16, v157
    v_lshl_or_b32 v137, v157, 16, v137
    v_lshl_or_b32 v178, v178, 16, v158
    v_lshl_or_b32 v138, v158, 16, v138
    v_lshl_or_b32 v179, v179, 16, v159
    v_lshl_or_b32 v139, v159, 16, v139
    v_lshl_or_b32 v180, v180, 16, v160
    v_lshl_or_b32 v140, v160, 16, v140
    v_lshl_or_b32 v181, v181, 16, v161
    v_lshl_or_b32 v141, v161, 16, v141
    v_lshl_or_b32 v182, v182, 16, v162
    v_lshl_or_b32 v142, v162, 16, v142
    v_lshl_or_b32 v183, v183, 16, v163
    v_lshl_or_b32 v143, v163, 16, v143
    v_lshl_or_b32 v184, v184, 16, v164
    v_lshl_or_b32 v144, v164, 16, v144
    v_lshl_or_b32 v185, v185, 16, v165
    v_lshl_or_b32 v145, v165, 16, v145
    s_mul_i32 s67, s62, 16640
    s_add_u32 s67, s67, 96000
    v_and_b32 v20, 3, v1
    v_lshlrev_b32 v20, 2, v20
    v_add_u32 v20, 112, v20
    s_mov_b32 s77, 0
L_lw16:
    ds_read_b32 v21, v20
    s_waitcnt lgkmcnt(0)
    v_cmp_ne_u32 vcc, 0, v21
    s_nop 0
    s_cmp_eq_u64 vcc, -1
    s_cbranch_scc1 L_lx16
    s_add_u32 s77, s77, 1
    s_cmp_ge_u32 s77, 160000
    s_cbranch_scc1 L_lx16
    s_sleep 1
    s_branch L_lw16
L_lx16:
    v_lshl_add_u32 v40, v1, 2, s67
    v_add_u32 v41, 16, v40
    v_add_u32 v42, 4172, v40
    v_add_u32 v43, 8332, v40
    v_add_u32 v44, 12488, v40
    ds_write2st64_b32 v41, v170, v171 offset0:0 offset1:1
    ds_write2st64_b32 v42, v130, v131 offset0:0 offset1:1
    ds_write2st64_b32 v43, v170, v171 offset0:0 offset1:1
    ds_write2st64_b32 v44, v130, v131 offset0:0 offset1:1
    ds_write2st64_b32 v41, v172, v173 offset0:2 offset1:3
    ds_write2st64_b32 v42, v132, v133 offset0:2 offset1:3
    ds_write2st64_b32 v43, v172, v173 offset0:2 offset1:3
    ds_write2st64_b32 v44, v132, v133 offset0:2 offset1:3
    ds_write2st64_b32 v41, v174, v175 offset0:4 offset1:5
    ds_write2st64_b32 v42, v134, v135 offset0:4 offset1:5
    ds_write2st64_b32 v43, v174, v175 offset0:4 offset1:5
    ds_write2st64_b32 v44, v134, v135 offset0:4 offset1:5
    ds_write2st64_b32 v41, v176, v177 offset0:6 offset1:7
    ds_write2st64_b32 v42, v136, v137 offset0:6 offset1:7
    ds_write2st64_b32 v43, v176, v177 offset0:6 offset1:7
    ds_write2st64_b32 v44, v136, v137 offset0:6 offset1:7
    ds_write2st64_b32 v41, v178, v179 offset0:8 offset1:9
    ds_write2st64_b32 v42, v138, v139 offset0:8 offset1:9
    ds_write2st64_b32 v43, v178, v179 offset0:8 offset1:9
    ds_write2st64_b32 v44, v138, v139 offset0:8 offset1:9
    ds_write2st64_b32 v41, v180, v181 offset0:10 offset1:11
    ds_write2st64_b32 v42, v140, v141 offset0:10 offset1:11
    ds_write2st64_b32 v43, v180, v181 offset0:10 offset1:11
    ds_write2st64_b32 v44, v140, v141 offset0:10 offset1:11
    ds_write2st64_b32 v41, v182, v183 offset0:12 offset1:13
    ds_write2st64_b32 v42, v142, v143 offset0:12 offset1:13
    ds_write2st64_b32 v43, v182, v183 offset0:12 offset1:13
    ds_write2st64_b32 v44, v142, v143 offset0:12 offset1:13
    ds_write2st64_b32 v41, v184, v185 offset0:14 offset1:15
    ds_write2st64_b32 v42, v144, v145 offset0:14 offset1:15
    ds_write2st64_b32 v43, v184, v185 offset0:14 offset1:15
    ds_write2st64_b32 v44, v144, v145 offset0:14 offset1:15
    s_mov_b64 exec, 0x3ff
    ds_write_b32 v41, v186 offset:4096
    ds_write_b32 v42, v146 offset:4096
    ds_write_b32 v43, v186 offset:4096
    ds_write_b32 v44, v146 offset:4096
    s_mov_b64 exec, -1
    s_lshl_b32 s68, s62, 2
    s_add_u32 s68, s68, 48
    v_mov_b32 v20, s68
    v_mov_b32 v21, 12
    s_mov_b64 exec, 1
    ds_write_b32 v20, v21
    s_mov_b64 exec, -1
    s_nop 0
L_conv:
    s_sub_u32 s62, s3, 4
    s_lshr_b32 s65, s62, 1
    s_and_b32 s66, s2, 1
    s_mul_i32 s66, s66, 3
    s_add_u32 s63, s58, s66
    s_add_u32 s63, s63, s65
    v_mov_b32 v2, v240
    v_mov_b32 v3, v241
    v_mov_b32 v6, v242
    v_mov_b32 v7, v243
    v_mov_b32 v4, v244
    v_mov_b32 v8, 0
    v_mov_b32 v9, 0
    v_mov_b32 v10, 0
    v_mov_b32 v11, 0
    v_mov_b32 v12, 0
    v_mov_b32 v13, 0
    v_mov_b32 v14, 0
    v_mov_b32 v15, 0
    v_mov_b32 v16, 0
    v_mov_b32 v17, 0
    v_mov_b32 v18, 0
    v_mov_b32 v19, 0
    v_mov_b32 v20, 0
    v_mov_b32 v21, 0
    v_mov_b32 v22, 0
    v_mov_b32 v23, 0
    v_mov_b32 v24, 0
    v_mov_b32 v25, 0
    v_mov_b32 v26, 0
    v_mov_b32 v27, 0
    v_mov_b32 v28, 0
    v_mov_b32 v29, 0
    v_mov_b32 v30, 0
    v_mov_b32 v31, 0
    v_mov_b32 v32, 0
    v_mov_b32 v33, 0
    v_mov_b32 v34, 0
    v_mov_b32 v35, 0
    v_mov_b32 v36, 0
    v_mov_b32 v37, 0
    v_mov_b32 v38, 0
    v_mov_b32 v39, 0
    v_and_b32 v5, 3, v1
    v_lshlrev_b32 v5, 2, v5
    v_add_u32 v5, 48, v5
    s_lshl_b32 s65, s62, 2
    s_add_u32 s65, s65, 16
    v_writelane_b32 v5, s65, 4
    s_mov_b32 s77, 0
L_lw17:
    ds_read_b32 v170, v5
    s_waitcnt lgkmcnt(0)
    v_cmp_le_u32 vcc, 12, v170
    s_nop 0
    s_cmp_eq_u64 vcc, -1
    s_cbranch_scc1 L_lx17
    s_add_u32 s77, s77, 1
    s_cmp_ge_u32 s77, 160000
    s_cbranch_scc1 L_lx17
    s_sleep 1
    s_branch L_lw17
L_lx17:
    s_setprio 3
    ds_read_b64 v[40:41], v2 offset:3584
    ds_read_b64 v[42:43], v2 offset:3592
    ds_read_b128 v[72:75], v3 offset:0
    ds_read_b64 v[44:45], v2 offset:3072
    ds_read_b64 v[46:47], v2 offset:3080
    ds_read_b128 v[76:79], v3 offset:512
    ds_read_b64 v[48:49], v2 offset:2560
    ds_read_b64 v[50:51], v2 offset:2568
    ds_read_b128 v[80:83], v3 offset:1024
    ds_read_b64 v[52:53], v2 offset:2048
    ds_read_b64 v[54:55], v2 offset:2056
    ds_read_b128 v[84:87], v3 offset:1536
    ds_read_b64 v[56:57], v2 offset:1536
    ds_read_b64 v[58:59], v2 offset:1544
    ds_read_b128 v[88:91], v3 offset:2048
    ds_read_b64 v[60:61], v2 offset:1024
    ds_read_b64 v[62:63], v2 offset:1032
    ds_read_b128 v[92:95], v3 offset:2560
    ds_read_b64 v[64:65], v2 offset:512
    ds_read_b64 v[66:67], v2 offset:520
    ds_read_b128 v[96:99], v3 offset:3072
    ds_read_b64 v[68:69], v2 offset:0
    ds_read_b64 v[70:71], v2 offset:8
    ds_read_b128 v[100:103], v3 offset:3584
    s_lshl_b32 s65, s62, 2
    s_add_u32 s65, s65, 144
    v_mov_b32 v184, s65
    v_xor_b32 v5, 4, v184
    s_lshl_b32 s65, s62, 12
    s_add_u32 s65, s65, 145920
    v_lshl_add_u32 v187, v1, 4, s65
    s_mov_b32 s64, 0
L_cv_loop:
    s_waitcnt lgkmcnt(0)
    v_mfma_f32_16x16x32_bf16 v[8:11], v[40:43], v[72:75], v[8:11]
    ds_read_b64 v[104:105], v2 offset:3648
    v_mfma_f32_16x16x32_bf16 v[12:15], v[40:43], v[76:79], v[12:15]
    ds_read_b64 v[106:107], v2 offset:3656
    v_mfma_f32_16x16x32_bf16 v[12:15], v[44:47], v[72:75], v[12:15]
    ds_read_b128 v[136:139], v3 offset:64
    v_mfma_f32_16x16x32_bf16 v[16:19], v[40:43], v[80:83], v[16:19]
    ds_read_b64 v[108:109], v2 offset:3136
    v_mfma_f32_16x16x32_bf16 v[16:19], v[44:47], v[76:79], v[16:19]
    ds_read_b64 v[110:111], v2 offset:3144
    v_mfma_f32_16x16x32_bf16 v[16:19], v[48:51], v[72:75], v[16:19]
    ds_read_b128 v[140:143], v3 offset:576
    v_mfma_f32_16x16x32_bf16 v[20:23], v[40:43], v[84:87], v[20:23]
    ds_read_b64 v[112:113], v2 offset:2624
    v_mfma_f32_16x16x32_bf16 v[20:23], v[44:47], v[80:83], v[20:23]
    ds_read_b64 v[114:115], v2 offset:2632
    v_mfma_f32_16x16x32_bf16 v[20:23], v[48:51], v[76:79], v[20:23]
    v_mfma_f32_16x16x32_bf16 v[20:23], v[52:55], v[72:75], v[20:23]
    ds_read_b128 v[144:147], v3 offset:1088
    v_mfma_f32_16x16x32_bf16 v[24:27], v[40:43], v[88:91], v[24:27]
    ds_read_b64 v[116:117], v2 offset:2112
    v_mfma_f32_16x16x32_bf16 v[24:27], v[44:47], v[84:87], v[24:27]
    ds_read_b64 v[118:119], v2 offset:2120
    v_mfma_f32_16x16x32_bf16 v[24:27], v[48:51], v[80:83], v[24:27]
    ds_read_b128 v[148:151], v3 offset:1600
    v_mfma_f32_16x16x32_bf16 v[24:27], v[52:55], v[76:79], v[24:27]
    ds_read_b64 v[120:121], v2 offset:1600
    v_mfma_f32_16x16x32_bf16 v[24:27], v[56:59], v[72:75], v[24:27]
    ds_read_b64 v[122:123], v2 offset:1608
    v_mfma_f32_16x16x32_bf16 v[28:31], v[40:43], v[92:95], v[28:31]
    ds_read_b128 v[152:155], v3 offset:2112
    v_mfma_f32_16x16x32_bf16 v[28:31], v[44:47], v[88:91], v[28:31]
    ds_read_b64 v[124:125], v2 offset:1088
    v_mfma_f32_16x16x32_bf16 v[28:31], v[48:51], v[84:87], v[28:31]
    v_mfma_f32_16x16x32_bf16 v[28:31], v[52:55], v[80:83], v[28:31]
    ds_read_b64 v[126:127], v2 offset:1096
    v_mfma_f32_16x16x32_bf16 v[28:31], v[56:59], v[76:79], v[28:31]
    ds_read_b128 v[156:159], v3 offset:2624
    v_mfma_f32_16x16x32_bf16 v[28:31], v[60:63], v[72:75], v[28:31]
    ds_read_b64 v[128:129], v2 offset:576
    v_mfma_f32_16x16x32_bf16 v[32:35], v[40:43], v[96:99], v[32:35]
    ds_read_b64 v[130:131], v2 offset:584
    v_mfma_f32_16x16x32_bf16 v[32:35], v[44:47], v[92:95], v[32:35]
    ds_read_b128 v[160:163], v3 offset:3136
    v_mfma_f32_16x16x32_bf16 v[32:35], v[48:51], v[88:91], v[32:35]
    ds_read_b64 v[132:133], v2 offset:64
    v_mfma_f32_16x16x32_bf16 v[32:35], v[52:55], v[84:87], v[32:35]
    ds_read_b64 v[134:135], v2 offset:72
    v_mfma_f32_16x16x32_bf16 v[32:35], v[56:59], v[80:83], v[32:35]
    ds_read_b128 v[164:167], v3 offset:3648
    v_mfma_f32_16x16x32_bf16 v[32:35], v[60:63], v[76:79], v[32:35]
    v_mfma_f32_16x16x32_bf16 v[32:35], v[64:67], v[72:75], v[32:35]
    v_mfma_f32_16x16x32_bf16 v[36:39], v[40:43], v[100:103], v[36:39]
    v_mfma_f32_16x16x32_bf16 v[36:39], v[44:47], v[96:99], v[36:39]
    v_mfma_f32_16x16x32_bf16 v[36:39], v[48:51], v[92:95], v[36:39]
    v_mfma_f32_16x16x32_bf16 v[36:39], v[52:55], v[88:91], v[36:39]
    v_mfma_f32_16x16x32_bf16 v[36:39], v[56:59], v[84:87], v[36:39]
    v_mfma_f32_16x16x32_bf16 v[36:39], v[60:63], v[80:83], v[36:39]
    v_mfma_f32_16x16x32_bf16 v[36:39], v[64:67], v[76:79], v[36:39]
    v_mfma_f32_16x16x32_bf16 v[36:39], v[68:71], v[72:75], v[36:39]
    s_cmp_eq_u32 s64, 0
    s_cselect_b64 vcc, -1, 0
    v_add_u32 v2, 128, v2
    v_add_u32 v3, 128, v3
    v_cndmask_b32 v2, v6, v2, vcc
    v_cndmask_b32 v3, v7, v3, vcc
    v_mov_b32 v185, s64
    s_waitcnt lgkmcnt(0)
    v_mfma_f32_16x16x32_bf16 v[8:11], v[104:107], v[136:139], v[8:11]
    ds_read_b64 v[40:41], v2 offset:3584
    v_mfma_f32_16x16x32_bf16 v[12:15], v[104:107], v[140:143], v[12:15]
    ds_read_b64 v[42:43], v2 offset:3592
    v_mfma_f32_16x16x32_bf16 v[12:15], v[108:111], v[136:139], v[12:15]
    ds_read_b128 v[72:75], v3 offset:0
    v_mfma_f32_16x16x32_bf16 v[16:19], v[104:107], v[144:147], v[16:19]
    ds_read_b64 v[44:45], v2 offset:3072
    v_mfma_f32_16x16x32_bf16 v[16:19], v[108:111], v[140:143], v[16:19]
    ds_read_b64 v[46:47], v2 offset:3080
    v_mfma_f32_16x16x32_bf16 v[16:19], v[112:115], v[136:139], v[16:19]
    ds_read_b128 v[76:79], v3 offset:512
    v_mfma_f32_16x16x32_bf16 v[20:23], v[104:107], v[148:151], v[20:23]
    ds_read_b64 v[48:49], v2 offset:2560
    v_mfma_f32_16x16x32_bf16 v[20:23], v[108:111], v[144:147], v[20:23]
    ds_read_b64 v[50:51], v2 offset:2568
    v_mfma_f32_16x16x32_bf16 v[20:23], v[112:115], v[140:143], v[20:23]
    ds_read_b128 v[80:83], v3 offset:1024
    v_mfma_f32_16x16x32_bf16 v[20:23], v[116:119], v[136:139], v[20:23]
    ds_read_b64 v[52:53], v2 offset:2048
    v_mfma_f32_16x16x32_bf16 v[24:27], v[104:107], v[152:155], v[24:27]
    ds_read_b64 v[54:55], v2 offset:2056
    v_mfma_f32_16x16x32_bf16 v[24:27], v[108:111], v[148:151], v[24:27]
    ds_read_b128 v[84:87], v3 offset:1536
    v_mfma_f32_16x16x32_bf16 v[24:27], v[112:115], v[144:147], v[24:27]
    ds_read_b64 v[56:57], v2 offset:1536
    v_mfma_f32_16x16x32_bf16 v[24:27], v[116:119], v[140:143], v[24:27]
    v_mfma_f32_16x16x32_bf16 v[24:27], v[120:123], v[136:139], v[24:27]
    ds_read_b64 v[58:59], v2 offset:1544
    v_mfma_f32_16x16x32_bf16 v[28:31], v[104:107], v[156:159], v[28:31]
    ds_read_b128 v[88:91], v3 offset:2048
    v_mfma_f32_16x16x32_bf16 v[28:31], v[108:111], v[152:155], v[28:31]
    ds_read_b64 v[60:61], v2 offset:1024
    v_mfma_f32_16x16x32_bf16 v[28:31], v[112:115], v[148:151], v[28:31]
    ds_read_b64 v[62:63], v2 offset:1032
    v_mfma_f32_16x16x32_bf16 v[28:31], v[116:119], v[144:147], v[28:31]
    ds_read_b128 v[92:95], v3 offset:2560
    v_mfma_f32_16x16x32_bf16 v[28:31], v[120:123], v[140:143], v[28:31]
    ds_read_b64 v[64:65], v2 offset:512
    v_mfma_f32_16x16x32_bf16 v[28:31], v[124:127], v[136:139], v[28:31]
    ds_read_b64 v[66:67], v2 offset:520
    v_mfma_f32_16x16x32_bf16 v[32:35], v[104:107], v[160:163], v[32:35]
    ds_read_b128 v[96:99], v3 offset:3072
    v_mfma_f32_16x16x32_bf16 v[32:35], v[108:111], v[156:159], v[32:35]
    ds_read_b64 v[68:69], v2 offset:0
    v_mfma_f32_16x16x32_bf16 v[32:35], v[112:115], v[152:155], v[32:35]
    ds_read_b64 v[70:71], v2 offset:8
    v_mfma_f32_16x16x32_bf16 v[32:35], v[116:119], v[148:151], v[32:35]
    ds_read_b128 v[100:103], v3 offset:3584
    v_mfma_f32_16x16x32_bf16 v[32:35], v[120:123], v[144:147], v[32:35]
    s_mov_b64 exec, 1
    ds_write_b32 v184, v185
    s_mov_b64 exec, -1
    v_mfma_f32_16x16x32_bf16 v[32:35], v[124:127], v[140:143], v[32:35]
    v_mfma_f32_16x16x32_bf16 v[32:35], v[128:131], v[136:139], v[32:35]
    v_mfma_f32_16x16x32_bf16 v[36:39], v[104:107], v[164:167], v[36:39]
    v_mfma_f32_16x16x32_bf16 v[36:39], v[108:111], v[160:163], v[36:39]
    v_mfma_f32_16x16x32_bf16 v[36:39], v[112:115], v[156:159], v[36:39]
    v_mfma_f32_16x16x32_bf16 v[36:39], v[116:119], v[152:155], v[36:39]
    v_mfma_f32_16x16x32_bf16 v[36:39], v[120:123], v[148:151], v[36:39]
    v_mfma_f32_16x16x32_bf16 v[36:39], v[124:127], v[144:147], v[36:39]
    v_mfma_f32_16x16x32_bf16 v[36:39], v[128:131], v[140:143], v[36:39]
    v_mfma_f32_16x16x32_bf16 v[36:39], v[132:135], v[136:139], v[36:39]
    s_add_u32 s64, s64, 1
    s_cmp_lt_u32 s64, 2
    s_cbranch_scc1 L_cv_loop
    s_and_b32 s64, s2, 1
    s_cbranch_scc1 L_cv_odd
    s_waitcnt lgkmcnt(0)
    v_mfma_f32_16x16x32_bf16 v[168:171], v[40:43], v[72:75], 0
    ds_read_b64 v[104:105], v2 offset:3648
    ds_read_b64 v[106:107], v2 offset:3656
    v_mfma_f32_16x16x32_bf16 v[172:175], v[40:43], v[84:87], 0
    ds_read_b128 v[136:139], v3 offset:64
    ds_read_b64 v[108:109], v2 offset:3136
    v_mfma_f32_16x16x32_bf16 v[172:175], v[44:47], v[80:83], v[172:175]
    ds_read_b64 v[110:111], v2 offset:3144
    v_mfma_f32_16x16x32_bf16 v[172:175], v[48:51], v[76:79], v[172:175]
    ds_read_b128 v[140:143], v3 offset:576
    ds_read_b64 v[112:113], v2 offset:2624
    v_mfma_f32_16x16x32_bf16 v[172:175], v[52:55], v[72:75], v[172:175]
    ds_read_b64 v[114:115], v2 offset:2632
    ds_read_b128 v[144:147], v3 offset:1088
    v_mfma_f32_16x16x32_bf16 v[176:179], v[40:43], v[88:91], 0
    ds_read_b64 v[116:117], v2 offset:2112
    v_mfma_f32_16x16x32_bf16 v[176:179], v[44:47], v[84:87], v[176:179]
    ds_read_b64 v[118:119], v2 offset:2120
    ds_read_b128 v[148:151], v3 offset:1600
    v_mfma_f32_16x16x32_bf16 v[176:179], v[48:51], v[80:83], v[176:179]
    ds_read_b64 v[120:121], v2 offset:1600
    ds_read_b64 v[122:123], v2 offset:1608
    v_mfma_f32_16x16x32_bf16 v[176:179], v[52:55], v[76:79], v[176:179]
    ds_read_b128 v[152:155], v3 offset:2112
    v_mfma_f32_16x16x32_bf16 v[176:179], v[56:59], v[72:75], v[176:179]
    ds_read_b64 v[124:125], v2 offset:1088
    ds_read_b64 v[126:127], v2 offset:1096
    v_mfma_f32_16x16x32_bf16 v[180:183], v[40:43], v[100:103], 0
    ds_read_b128 v[156:159], v3 offset:2624
    ds_read_b64 v[128:129], v2 offset:576
    v_mfma_f32_16x16x32_bf16 v[180:183], v[44:47], v[96:99], v[180:183]
    ds_read_b64 v[130:131], v2 offset:584
    v_mfma_f32_16x16x32_bf16 v[180:183], v[48:51], v[92:95], v[180:183]
    ds_read_b128 v[160:163], v3 offset:3136
    ds_read_b64 v[132:133], v2 offset:64
    v_mfma_f32_16x16x32_bf16 v[180:183], v[52:55], v[88:91], v[180:183]
    ds_read_b64 v[134:135], v2 offset:72
    ds_read_b128 v[164:167], v3 offset:3648
    v_mfma_f32_16x16x32_bf16 v[180:183], v[56:59], v[84:87], v[180:183]
    v_mfma_f32_16x16x32_bf16 v[180:183], v[60:63], v[80:83], v[180:183]
    v_mfma_f32_16x16x32_bf16 v[180:183], v[64:67], v[76:79], v[180:183]
    v_mfma_f32_16x16x32_bf16 v[180:183], v[68:71], v[72:75], v[180:183]
    s_mov_b32 s77, 0
L_lw18:
    ds_read_b32 v186, v5
    s_waitcnt lgkmcnt(0)
    v_cmp_ne_u32 vcc, 0, v186
    s_nop 0
    s_cmp_eq_u64 vcc, -1
    s_cbranch_scc1 L_lx18
    s_add_u32 s77, s77, 1
    s_cmp_ge_u32 s77, 160000
    s_cbranch_scc1 L_lx18
    s_branch L_lw18
L_lx18:
    s_waitcnt lgkmcnt(0)
    v_mfma_f32_16x16x32_bf16 v[168:171], v[104:107], v[136:139], v[168:171]
    ds_write_b128 v4, v[8:11] offset:0
    v_mfma_f32_16x16x32_bf16 v[172:175], v[104:107], v[148:151], v[172:175]
    v_mfma_f32_16x16x32_bf16 v[172:175], v[108:111], v[144:147], v[172:175]
    ds_write_b128 v4, v[12:15] offset:1024
    v_mfma_f32_16x16x32_bf16 v[172:175], v[112:115], v[140:143], v[172:175]
    v_mfma_f32_16x16x32_bf16 v[172:175], v[116:119], v[136:139], v[172:175]
    ds_write_b128 v4, v[16:19] offset:2048
    v_mfma_f32_16x16x32_bf16 v[176:179], v[104:107], v[152:155], v[176:179]
    v_mfma_f32_16x16x32_bf16 v[176:179], v[108:111], v[148:151], v[176:179]
    ds_write_b128 v4, v[20:23] offset:3072
    v_mfma_f32_16x16x32_bf16 v[176:179], v[112:115], v[144:147], v[176:179]
    v_mfma_f32_16x16x32_bf16 v[176:179], v[116:119], v[140:143], v[176:179]
    ds_write_b128 v4, v[24:27] offset:4096
    v_mfma_f32_16x16x32_bf16 v[176:179], v[120:123], v[136:139], v[176:179]
    v_mfma_f32_16x16x32_bf16 v[180:183], v[104:107], v[164:167], v[180:183]
    ds_write_b128 v4, v[28:31] offset:5120
    v_mfma_f32_16x16x32_bf16 v[180:183], v[108:111], v[160:163], v[180:183]
    v_mfma_f32_16x16x32_bf16 v[180:183], v[112:115], v[156:159], v[180:183]
    ds_write_b128 v4, v[32:35] offset:6144
    v_mfma_f32_16x16x32_bf16 v[180:183], v[116:119], v[152:155], v[180:183]
    v_mfma_f32_16x16x32_bf16 v[180:183], v[120:123], v[148:151], v[180:183]
    ds_write_b128 v4, v[36:39] offset:7168
    v_mfma_f32_16x16x32_bf16 v[180:183], v[124:127], v[144:147], v[180:183]
    v_mfma_f32_16x16x32_bf16 v[180:183], v[128:131], v[140:143], v[180:183]
    v_mfma_f32_16x16x32_bf16 v[180:183], v[132:135], v[136:139], v[180:183]
    s_branch L_cv_join
L_cv_odd:
    s_waitcnt lgkmcnt(0)
    v_mfma_f32_16x16x32_bf16 v[168:171], v[40:43], v[76:79], 0
    ds_read_b64 v[104:105], v2 offset:3648
    ds_read_b64 v[106:107], v2 offset:3656
    v_mfma_f32_16x16x32_bf16 v[168:171], v[44:47], v[72:75], v[168:171]
    ds_read_b128 v[136:139], v3 offset:64
    v_mfma_f32_16x16x32_bf16 v[172:175], v[40:43], v[80:83], 0
    ds_read_b64 v[108:109], v2 offset:3136
    ds_read_b64 v[110:111], v2 offset:3144
    v_mfma_f32_16x16x32_bf16 v[172:175], v[44:47], v[76:79], v[172:175]
    ds_read_b128 v[140:143], v3 offset:576
    v_mfma_f32_16x16x32_bf16 v[172:175], v[48:51], v[72:75], v[172:175]
    ds_read_b64 v[112:113], v2 offset:2624
    ds_read_b64 v[114:115], v2 offset:2632
    v_mfma_f32_16x16x32_bf16 v[176:179], v[40:43], v[92:95], 0
    ds_read_b128 v[144:147], v3 offset:1088
    v_mfma_f32_16x16x32_bf16 v[176:179], v[44:47], v[88:91], v[176:179]
    ds_read_b64 v[116:117], v2 offset:2112
    ds_read_b64 v[118:119], v2 offset:2120
    v_mfma_f32_16x16x32_bf16 v[176:179], v[48:51], v[84:87], v[176:179]
    ds_read_b128 v[148:151], v3 offset:1600
    v_mfma_f32_16x16x32_bf16 v[176:179], v[52:55], v[80:83], v[176:179]
    ds_read_b64 v[120:121], v2 offset:1600
    ds_read_b64 v[122:123], v2 offset:1608
    v_mfma_f32_16x16x32_bf16 v[176:179], v[56:59], v[76:79], v[176:179]
    ds_read_b128 v[152:155], v3 offset:2112
    v_mfma_f32_16x16x32_bf16 v[176:179], v[60:63], v[72:75], v[176:179]
    ds_read_b64 v[124:125], v2 offset:1088
    ds_read_b64 v[126:127], v2 offset:1096
    v_mfma_f32_16x16x32_bf16 v[180:183], v[40:43], v[96:99], 0
    ds_read_b128 v[156:159], v3 offset:2624
    v_mfma_f32_16x16x32_bf16 v[180:183], v[44:47], v[92:95], v[180:183]
    ds_read_b64 v[128:129], v2 offset:576
    v_mfma_f32_16x16x32_bf16 v[180:183], v[48:51], v[88:91], v[180:183]
    ds_read_b64 v[130:131], v2 offset:584
    ds_read_b128 v[160:163], v3 offset:3136
    v_mfma_f32_16x16x32_bf16 v[180:183], v[52:55], v[84:87], v[180:183]
    v_mfma_f32_16x16x32_bf16 v[180:183], v[56:59], v[80:83], v[180:183]
    v_mfma_f32_16x16x32_bf16 v[180:183], v[60:63], v[76:79], v[180:183]
    v_mfma_f32_16x16x32_bf16 v[180:183], v[64:67], v[72:75], v[180:183]
    s_mov_b32 s77, 0
L_lw19:
    ds_read_b32 v186, v5
    s_waitcnt lgkmcnt(0)
    v_cmp_ne_u32 vcc, 0, v186
    s_nop 0
    s_cmp_eq_u64 vcc, -1
    s_cbranch_scc1 L_lx19
    s_add_u32 s77, s77, 1
    s_cmp_ge_u32 s77, 160000
    s_cbranch_scc1 L_lx19
    s_branch L_lw19
L_lx19:
    s_waitcnt lgkmcnt(0)
    v_mfma_f32_16x16x32_bf16 v[168:171], v[104:107], v[140:143], v[168:171]
    ds_write_b128 v4, v[8:11] offset:0
    v_mfma_f32_16x16x32_bf16 v[168:171], v[108:111], v[136:139], v[168:171]
    v_mfma_f32_16x16x32_bf16 v[172:175], v[104:107], v[144:147], v[172:175]
    ds_write_b128 v4, v[12:15] offset:1024
    v_mfma_f32_16x16x32_bf16 v[172:175], v[108:111], v[140:143], v[172:175]
    v_mfma_f32_16x16x32_bf16 v[172:175], v[112:115], v[136:139], v[172:175]
    ds_write_b128 v4, v[16:19] offset:2048
    v_mfma_f32_16x16x32_bf16 v[176:179], v[104:107], v[156:159], v[176:179]
    v_mfma_f32_16x16x32_bf16 v[176:179], v[108:111], v[152:155], v[176:179]
    ds_write_b128 v4, v[20:23] offset:3072
    v_mfma_f32_16x16x32_bf16 v[176:179], v[112:115], v[148:151], v[176:179]
    v_mfma_f32_16x16x32_bf16 v[176:179], v[116:119], v[144:147], v[176:179]
    ds_write_b128 v4, v[24:27] offset:4096
    v_mfma_f32_16x16x32_bf16 v[176:179], v[120:123], v[140:143], v[176:179]
    v_mfma_f32_16x16x32_bf16 v[176:179], v[124:127], v[136:139], v[176:179]
    ds_write_b128 v4, v[28:31] offset:5120
    v_mfma_f32_16x16x32_bf16 v[180:183], v[104:107], v[160:163], v[180:183]
    v_mfma_f32_16x16x32_bf16 v[180:183], v[108:111], v[156:159], v[180:183]
    ds_write_b128 v4, v[32:35] offset:6144
    v_mfma_f32_16x16x32_bf16 v[180:183], v[112:115], v[152:155], v[180:183]
    v_mfma_f32_16x16x32_bf16 v[180:183], v[116:119], v[148:151], v[180:183]
    ds_write_b128 v4, v[36:39] offset:7168
    v_mfma_f32_16x16x32_bf16 v[180:183], v[120:123], v[144:147], v[180:183]
    v_mfma_f32_16x16x32_bf16 v[180:183], v[124:127], v[140:143], v[180:183]
    v_mfma_f32_16x16x32_bf16 v[180:183], v[128:131], v[136:139], v[180:183]
L_cv_join:
    ds_write_b128 v187, v[168:171] offset:0
    ds_write_b128 v187, v[172:175] offset:1024
    ds_write_b128 v187, v[176:179] offset:2048
    s_nop 4
    ds_write_b128 v187, v[180:183] offset:3072
    s_lshl_b32 s69, s62, 2
    s_add_u32 s69, s69, 96
    v_mov_b32 v184, s69
    v_mov_b32 v185, 1
    s_mov_b64 exec, 1
    ds_write_b32 v184, v185
    s_mov_b64 exec, -1
L_cv_skip:
    s_mov_b32 s52, s32
    s_and_b32 s53, s33, 0xffff
    s_mov_b32 s54, 2621440
    s_mov_b32 s55, 0x20000
    v_and_b32 v2, 3, v1
    v_lshrrev_b32 v3, 2, v1
    v_lshlrev_b32 v6, 4, v2
    v_lshlrev_b32 v7, 3, v2
    v_mul_u32_u24 v5, 1280, v3
    v_add_u32 v4, v5, v7
    v_add_u32 v5, v5, v6
    s_lshl_b32 s66, s56, 2
    s_add_u32 s66, s66, s62
    s_mul_i32 s66, s66, 20480
    s_mul_i32 s67, s57, 160
    s_add_u32 s66, s66, s67
    v_lshlrev_b32 v34, 2, v2
    v_add_u32 v34, 96, v34
    v_lshrrev_b32 v30, 3, v1
    v_and_b32 v32, 7, v1
    v_mul_u32_u24 v36, 82048, v30
    v_lshl_add_u32 v36, v32, 4, v36
    s_and_b32 s68, s2, 1
    v_lshrrev_b32 v39, 5, v1
    v_mul_u32_u24 v37, 3, v39
    v_xor_b32 v37, s68, v37
    v_and_b32 v38, 3, v30
    v_lshl_add_u32 v37, v37, 2, v38
    v_mul_u32_u24 v37, 82048, v37
    v_lshl_add_u32 v37, v32, 4, v37
    v_lshlrev_b32 v38, 10, v39
    v_and_b32 v39, 1, v1
    v_lshl_add_u32 v38, v39, 9, v38
    v_bfe_u32 v39, v1, 1, 4
    v_lshl_add_u32 v38, v39, 4, v38
    s_and_b32 s68, s62, 1
    s_lshl_b32 s70, s68, 11
    s_add_u32 s70, s70, 145920
    v_add_u32 v39, s70, v38
    s_lshr_b32 s70, s62, 1
    s_mul_i32 s70, s70, 16640
    s_lshl_b32 s71, s68, 12
    s_add_u32 s70, s70, s71
    s_add_u32 s70, s70, 96000
    v_add_u32 v38, s70, v38
    s_mul_i32 s71, s68, 1312768
    s_mul_i32 s70, s63, 128
    s_add_u32 s70, s70, s71
    s_add_u32 s69, s58, 2
    s_mul_i32 s69, s69, 128
    s_add_u32 s71, s71, s69
    s_add_u32 s71, s71, 2883584
    s_mov_b32 s77, 0
L_lw20:
    ds_read_b32 v35, v34
    s_waitcnt lgkmcnt(0)
    v_cmp_ne_u32 vcc, 0, v35
    s_nop 0
    s_cmp_eq_u64 vcc, -1
    s_cbranch_scc1 L_lx20
    s_add_u32 s77, s77, 1
    s_cmp_ge_u32 s77, 160000
    s_cbranch_scc1 L_lx20
    s_branch L_lw20
L_lx20:
    ds_read_b128 v[104:107], v38 offset:0
    ds_read_b128 v[108:111], v38 offset:256
    ds_read_b128 v[112:115], v38 offset:8192
    ds_read_b128 v[116:119], v38 offset:8448
    ds_read_b128 v[120:123], v38 offset:2048
    ds_read_b128 v[124:127], v38 offset:2304
    ds_read_b128 v[128:131], v38 offset:10240
    ds_read_b128 v[132:135], v38 offset:10496
    ds_read_b128 v[136:139], v39 offset:0
    ds_read_b128 v[140:143], v39 offset:256
    ds_read_b128 v[144:147], v39 offset:4096
    ds_read_b128 v[148:151], v39 offset:4352
    ds_read_b128 v[152:155], v39 offset:8192
    ds_read_b128 v[156:159], v39 offset:8448
    ds_read_b128 v[160:163], v39 offset:12288
    ds_read_b128 v[164:167], v39 offset:12544
    s_waitcnt lgkmcnt(12)
    v_add_f32 v104, v104, v112
    v_add_f32 v105, v105, v113
    v_add_f32 v106, v106, v114
    v_add_f32 v107, v107, v115
    v_add_f32 v108, v108, v116
    v_add_f32 v109, v109, v117
    v_add_f32 v110, v110, v118
    v_add_f32 v111, v111, v119
    v_cvt_pk_bf16_f32 v112, v104, v105
    v_cvt_pk_bf16_f32 v113, v106, v107
    v_cvt_pk_bf16_f32 v114, v108, v109
    v_cvt_pk_bf16_f32 v115, v110, v111
    s_add_u32 s69, s70, 2883584
    buffer_store_dwordx4 v[112:115], v36, s[40:43], s69 offen sc1
    s_waitcnt lgkmcnt(8)
    v_add_f32 v120, v120, v128
    v_add_f32 v121, v121, v129
    v_add_f32 v122, v122, v130
    v_add_f32 v123, v123, v131
    v_add_f32 v124, v124, v132
    v_add_f32 v125, v125, v133
    v_add_f32 v126, v126, v134
    v_add_f32 v127, v127, v135
    v_cvt_pk_bf16_f32 v128, v120, v121
    v_cvt_pk_bf16_f32 v129, v122, v123
    v_cvt_pk_bf16_f32 v130, v124, v125
    v_cvt_pk_bf16_f32 v131, v126, v127
    s_add_u32 s69, s70, 3539968
    buffer_store_dwordx4 v[128:131], v36, s[40:43], s69 offen sc1
    s_waitcnt lgkmcnt(0)
    s_cmp_ge_u32 s62, 2
    s_cbranch_scc1 L_fin_ld
    v_add_f32 v136, v136, v144
    v_add_f32 v137, v137, v145
    v_add_f32 v138, v138, v146
    v_add_f32 v139, v139, v147
    v_add_f32 v140, v140, v148
    v_add_f32 v141, v141, v149
    v_add_f32 v142, v142, v150
    v_add_f32 v143, v143, v151
    v_add_f32 v152, v152, v160
    v_add_f32 v153, v153, v161
    v_add_f32 v154, v154, v162
    v_add_f32 v155, v155, v163
    v_add_f32 v156, v156, v164
    v_add_f32 v157, v157, v165
    v_add_f32 v158, v158, v166
    v_add_f32 v159, v159, v167
    v_add_f32 v136, v136, v152
    v_add_f32 v137, v137, v153
    v_add_f32 v138, v138, v154
    v_add_f32 v139, v139, v155
    v_add_f32 v140, v140, v156
    v_add_f32 v141, v141, v157
    v_add_f32 v142, v142, v158
    v_add_f32 v143, v143, v159
    v_cvt_pk_bf16_f32 v144, v136, v137
    v_cvt_pk_bf16_f32 v145, v138, v139
    v_cvt_pk_bf16_f32 v146, v140, v141
    v_cvt_pk_bf16_f32 v147, v142, v143
    buffer_store_dwordx4 v[144:147], v37, s[40:43], s71 offen sc1
L_fin_ld:
    s_lshl_b32 s69, s62, 2
    s_add_u32 s69, s69, 128
    s_waitcnt vmcnt(0)
    v_mov_b32 v30, s69
    v_mov_b32 v31, 1
    s_mov_b64 exec, 1
    ds_write_b32 v30, v31
    s_mov_b64 exec, -1
    s_cmp_lg_u32 s62, 3
    s_cbranch_scc1 L_fin_nopub
    v_mov_b32 v30, 32
    s_mov_b32 s77, 0
L_lw21:
    ds_read_b32 v31, v30
    s_waitcnt lgkmcnt(0)
    v_cmp_ne_u32 vcc, 0, v31
    s_nop 0
    s_cmp_eq_u64 vcc, -1
    s_cbranch_scc1 L_lx21
    s_add_u32 s77, s77, 1
    s_cmp_ge_u32 s77, 160000
    s_cbranch_scc1 L_lx21
    s_sleep 1
    s_branch L_lw21
L_lx21:
    v_readfirstlane_b32 s59, v31
    v_add_u32 v34, 32, v34
    s_mov_b32 s77, 0
L_lw22:
    ds_read_b32 v35, v34
    s_waitcnt lgkmcnt(0)
    v_cmp_ne_u32 vcc, 0, v35
    s_nop 0
    s_cmp_eq_u64 vcc, -1
    s_cbranch_scc1 L_lx22
    s_add_u32 s77, s77, 1
    s_cmp_ge_u32 s77, 160000
    s_cbranch_scc1 L_lx22
    s_branch L_lw22
L_lx22:
    s_lshl_b32 s69, s2, 7
    s_add_u32 s69, s69, 15290368
    v_lshlrev_b32 v34, 2, v1
    v_mov_b32 v35, s59
    s_mov_b32 exec_hi, 0
    buffer_store_dword v35, v34, s[40:43], s69 offen sc1
    s_mov_b64 exec, -1
L_fin_nopub:
    s_setprio 0
    v_lshlrev_b32 v64, 16, v212
    v_and_b32 v65, 0xffff0000, v212
    v_lshlrev_b32 v84, 16, v248
    v_and_b32 v85, 0xffff0000, v248
    v_lshlrev_b32 v66, 16, v213
    v_and_b32 v67, 0xffff0000, v213
    v_lshlrev_b32 v86, 16, v249
    v_and_b32 v87, 0xffff0000, v249
    v_lshlrev_b32 v68, 16, v214
    v_and_b32 v69, 0xffff0000, v214
    v_lshlrev_b32 v88, 16, v250
    v_and_b32 v89, 0xffff0000, v250
    v_lshlrev_b32 v70, 16, v215
    v_and_b32 v71, 0xffff0000, v215
    v_lshlrev_b32 v90, 16, v251
    v_and_b32 v91, 0xffff0000, v251
    v_lshlrev_b32 v72, 16, v216
    v_and_b32 v73, 0xffff0000, v216
    v_lshlrev_b32 v92, 16, v252
    v_and_b32 v93, 0xffff0000, v252
    v_lshlrev_b32 v74, 16, v217
    v_and_b32 v75, 0xffff0000, v217
    v_lshlrev_b32 v94, 16, v253
    v_and_b32 v95, 0xffff0000, v253
    v_lshlrev_b32 v76, 16, v218
    v_and_b32 v77, 0xffff0000, v218
    v_lshlrev_b32 v96, 16, v254
    v_and_b32 v97, 0xffff0000, v254
    v_lshlrev_b32 v78, 16, v219
    v_and_b32 v79, 0xffff0000, v219
    v_lshlrev_b32 v98, 16, v255
    v_and_b32 v99, 0xffff0000, v255
    v_lshlrev_b32 v80, 16, v238
    v_and_b32 v81, 0xffff0000, v238
    v_lshlrev_b32 v100, 16, v246
    v_and_b32 v101, 0xffff0000, v246
    v_lshlrev_b32 v82, 16, v239
    v_and_b32 v83, 0xffff0000, v239
    v_lshlrev_b32 v102, 16, v247
    v_and_b32 v103, 0xffff0000, v247
    v_mov_b32 v40, 0
    v_mov_b32 v41, 0
    v_mov_b32 v42, 0
    v_mov_b32 v43, 0
    v_mov_b32 v44, 0
    v_mov_b32 v45, 0
    v_mov_b32 v46, 0
    v_mov_b32 v47, 0
    v_mov_b32 v48, 0
    v_mov_b32 v49, 0
    v_mov_b32 v50, 0
    v_mov_b32 v51, 0
    v_mov_b32 v52, 0
    v_mov_b32 v53, 0
    v_mov_b32 v54, 0
    v_mov_b32 v55, 0
    v_mov_b32 v56, 0
    v_mov_b32 v57, 0
    v_mov_b32 v58, 0
    v_mov_b32 v59, 0
    s_lshl_b32 s69, s62, 5
    s_add_u32 s69, s69, 145920
    v_lshl_add_u32 v30, v3, 1, s69
    v_mul_u32_u24 v31, 1040, v2
    v_add_u32 v31, v31, v30
    v_lshrrev_b32 v32, 1, v2
    v_mul_u32_u24 v32, 1040, v32
    v_and_b32 v33, 1, v2
    v_lshl_add_u32 v32, v33, 9, v32
    v_add_u32 v32, v32, v30
    v_lshlrev_b32 v36, 2, v2
    v_xor_b32 v36, v36, v3
    v_lshlrev_b32 v36, 4, v36
    s_lshl_b32 s69, s62, 10
    s_add_u32 s69, s69, 256
    v_add_u32 v36, s69, v36
    v_lshl_add_u32 v37, v2, 8, v36
    v_add_u32 v37, 16384, v37
    v_lshl_add_u32 v36, v33, 9, v36
    v_lshrrev_b32 v38, 1, v2
    v_lshl_add_u32 v36, v38, 12, v36
    v_add_u32 v38, 40960, v36
    v_add_u32 v39, 40960, v37
    s_cmp_lg_u32 s62, 3
    s_cbranch_scc1 L_fin_wait
    v_and_b32 v104, 31, v1
    v_lshlrev_b32 v104, 7, v104
    s_lshl_b32 s69, s57, 12
    s_add_u32 s69, s69, 15290368
    v_lshrrev_b32 v106, 3, v1
    v_mul_u32_u24 v106, 128, v106
    v_and_b32 v107, 7, v1
    v_lshl_add_u32 v106, v107, 4, v106
    s_mul_i32 s68, s57, 10240
    s_mul_i32 s70, s56, 82048
    s_add_u32 s68, s68, s70
    v_lshlrev_b32 v35, 2, v2
    v_add_u32 v35, 16, v35
    s_mov_b32 s77, 0
L_lw23:
    ds_read_b32 v33, v35
    s_waitcnt lgkmcnt(0)
    v_cmp_le_u32 vcc, 13, v33
    s_nop 0
    s_cmp_eq_u64 vcc, -1
    s_cbranch_scc1 L_lx23
    s_add_u32 s77, s77, 1
    s_cmp_ge_u32 s77, 160000
    s_cbranch_scc1 L_lx23
    s_sleep 3
    s_branch L_lw23
L_lx23:
    s_setprio 3
    s_mov_b32 s77, 0
L_gp24:
    buffer_load_dword v105, v104, s[40:43], s69 offen sc1
    s_waitcnt vmcnt(0)
    v_cmp_eq_u32 vcc, s59, v105
    s_nop 0
    s_cmp_eq_u64 vcc, -1
    s_cbranch_scc1 L_gx24
    s_add_u32 s77, s77, 1
    s_cmp_ge_u32 s77, 20000
    s_cbranch_scc1 L_gx24
    s_sleep 6
    s_branch L_gp24
L_gx24:
    s_setprio 3
    s_add_u32 s70, s68, 2883584
    s_mov_b32 m0, 145920
    s_nop 0
    buffer_load_dwordx4 v106, s[40:43], s70 offen sc1 lds
    s_add_u32 s70, s68, 2884608
    s_mov_b32 m0, 146960
    s_nop 0
    buffer_load_dwordx4 v106, s[40:43], s70 offen sc1 lds
    s_add_u32 s70, s68, 2885632
    s_mov_b32 m0, 148000
    s_nop 0
    buffer_load_dwordx4 v106, s[40:43], s70 offen sc1 lds
    s_add_u32 s70, s68, 2886656
    s_mov_b32 m0, 149040
    s_nop 0
    buffer_load_dwordx4 v106, s[40:43], s70 offen sc1 lds
    s_add_u32 s70, s68, 2887680
    s_mov_b32 m0, 150080
    s_nop 0
    buffer_load_dwordx4 v106, s[40:43], s70 offen sc1 lds
    s_add_u32 s70, s68, 2888704
    s_mov_b32 m0, 151120
    s_nop 0
    buffer_load_dwordx4 v106, s[40:43], s70 offen sc1 lds
    s_add_u32 s70, s68, 2889728
    s_mov_b32 m0, 152160
    s_nop 0
    buffer_load_dwordx4 v106, s[40:43], s70 offen sc1 lds
    s_add_u32 s70, s68, 2890752
    s_mov_b32 m0, 153200
    s_nop 0
    buffer_load_dwordx4 v106, s[40:43], s70 offen sc1 lds
    s_add_u32 s70, s68, 2891776
    s_mov_b32 m0, 154240
    s_nop 0
    buffer_load_dwordx4 v106, s[40:43], s70 offen sc1 lds
    s_add_u32 s70, s68, 2892800
    s_mov_b32 m0, 155280
    s_nop 0
    buffer_load_dwordx4 v106, s[40:43], s70 offen sc1 lds
    s_waitcnt vmcnt(0)
    v_mov_b32 v104, 44
    v_mov_b32 v105, 1
    s_mov_b64 exec, 1
    ds_write_b32 v104, v105
    s_mov_b64 exec, -1
L_fin_wait:
    v_mov_b32 v35, 44
    s_mov_b32 s77, 0
L_lw25:
    ds_read_b32 v33, v35
    s_waitcnt lgkmcnt(0)
    v_cmp_ne_u32 vcc, 0, v33
    s_nop 0
    s_cmp_eq_u64 vcc, -1
    s_cbranch_scc1 L_lx25
    s_add_u32 s77, s77, 1
    s_cmp_ge_u32 s77, 160000
    s_cbranch_scc1 L_lx25
    s_sleep 1
    s_branch L_lw25
L_lx25:
    ds_read_u16_d16_hi v40, v31 offset:0
    ds_read_u16_d16_hi v41, v31 offset:128
    ds_read_u16_d16_hi v42, v31 offset:256
    ds_read_u16_d16_hi v43, v31 offset:384
    ds_read_u16_d16_hi v44, v31 offset:512
    ds_read_u16_d16_hi v45, v31 offset:640
    ds_read_u16_d16_hi v46, v31 offset:768
    ds_read_u16_d16_hi v47, v31 offset:896
    ds_read_u16_d16_hi v48, v31 offset:4160
    ds_read_u16_d16_hi v49, v31 offset:4288
    ds_read_u16_d16_hi v50, v31 offset:4416
    ds_read_u16_d16_hi v51, v31 offset:4544
    ds_read_u16_d16_hi v52, v31 offset:4672
    ds_read_u16_d16_hi v53, v31 offset:4800
    ds_read_u16_d16_hi v54, v31 offset:4928
    ds_read_u16_d16_hi v55, v31 offset:5056
    ds_read_u16_d16_hi v56, v32 offset:8320
    ds_read_u16_d16_hi v57, v32 offset:8448
    ds_read_u16_d16_hi v58, v32 offset:8576
    ds_read_u16_d16_hi v59, v32 offset:8704
    s_mov_b32 s72, 0xbfb8aa3b
    s_mov_b32 s73, 0xbfb8aa3b
    s_setprio 3
    s_waitcnt lgkmcnt(0)
    s_barrier
    ds_read_b128 v[104:107], v36 offset:0
    ds_read_b128 v[108:111], v36 offset:256
    ds_read_b128 v[124:127], v36 offset:20480
    ds_read_b128 v[128:131], v36 offset:20736
    ds_read_b128 v[144:147], v38 offset:0
    ds_read_b128 v[148:151], v38 offset:256
    ds_read_b128 v[164:167], v38 offset:20480
    ds_read_b128 v[168:171], v38 offset:20736
    ds_read_b128 v[112:115], v36 offset:8192
    ds_read_b128 v[116:119], v36 offset:8448
    ds_read_b128 v[132:135], v36 offset:28672
    ds_read_b128 v[136:139], v36 offset:28928
    ds_read_b128 v[152:155], v38 offset:8192
    ds_read_b128 v[156:159], v38 offset:8448
    ds_read_b128 v[172:175], v38 offset:28672
    ds_read_b128 v[176:179], v38 offset:28928
    ds_read_b128 v[120:123], v37 offset:0
    ds_read_b128 v[140:143], v37 offset:20480
    ds_read_b128 v[160:163], v39 offset:0
    ds_read_b128 v[180:183], v39 offset:20480
    s_waitcnt lgkmcnt(12)
    v_pk_add_f32 v[104:105], v[104:105], v[124:125]
    v_pk_add_f32 v[106:107], v[106:107], v[126:127]
    v_pk_add_f32 v[108:109], v[108:109], v[128:129]
    v_pk_add_f32 v[110:111], v[110:111], v[130:131]
    v_pk_add_f32 v[144:145], v[144:145], v[164:165]
    v_pk_add_f32 v[146:147], v[146:147], v[166:167]
    v_pk_add_f32 v[148:149], v[148:149], v[168:169]
    v_pk_add_f32 v[150:151], v[150:151], v[170:171]
    v_pk_add_f32 v[104:105], v[104:105], v[84:85]
    v_pk_add_f32 v[106:107], v[106:107], v[86:87]
    v_pk_add_f32 v[108:109], v[108:109], v[88:89]
    v_pk_add_f32 v[110:111], v[110:111], v[90:91]
    v_pk_add_f32 v[104:105], v[104:105], v[144:145]
    v_pk_add_f32 v[106:107], v[106:107], v[146:147]
    v_pk_add_f32 v[108:109], v[108:109], v[148:149]
    v_pk_add_f32 v[110:111], v[110:111], v[150:151]
    v_pk_mul_f32 v[184:185], v[104:105], s[72:73]
    v_pk_mul_f32 v[186:187], v[106:107], s[72:73]
    v_pk_mul_f32 v[188:189], v[108:109], s[72:73]
    v_pk_mul_f32 v[190:191], v[110:111], s[72:73]
    v_exp_f32 v184, v184
    v_exp_f32 v185, v185
    v_exp_f32 v186, v186
    v_exp_f32 v187, v187
    v_exp_f32 v188, v188
    v_exp_f32 v189, v189
    v_exp_f32 v190, v190
    v_exp_f32 v191, v191
    v_pk_mul_f32 v[104:105], v[104:105], v[40:41]
    v_pk_mul_f32 v[106:107], v[106:107], v[42:43]
    v_pk_mul_f32 v[108:109], v[108:109], v[44:45]
    v_pk_mul_f32 v[110:111], v[110:111], v[46:47]
    v_pk_add_f32 v[184:185], v[184:185], 1.0 op_sel_hi:[1,0]
    v_pk_add_f32 v[186:187], v[186:187], 1.0 op_sel_hi:[1,0]
    v_pk_add_f32 v[188:189], v[188:189], 1.0 op_sel_hi:[1,0]
    v_pk_add_f32 v[190:191], v[190:191], 1.0 op_sel_hi:[1,0]
    v_rcp_f32 v184, v184
    v_rcp_f32 v185, v185
    v_rcp_f32 v186, v186
    v_rcp_f32 v187, v187
    v_rcp_f32 v188, v188
    v_rcp_f32 v189, v189
    v_rcp_f32 v190, v190
    v_rcp_f32 v191, v191
    v_pk_fma_f32 v[104:105], v[104:105], v[184:185], v[64:65]
    v_pk_fma_f32 v[106:107], v[106:107], v[186:187], v[66:67]
    v_pk_fma_f32 v[108:109], v[108:109], v[188:189], v[68:69]
    v_pk_fma_f32 v[110:111], v[110:111], v[190:191], v[70:71]
    v_cvt_pk_bf16_f32 v204, v104, v105
    v_cvt_pk_bf16_f32 v205, v106, v107
    v_cvt_pk_bf16_f32 v206, v108, v109
    v_cvt_pk_bf16_f32 v207, v110, v111
    buffer_store_dwordx4 v[204:207], v5, s[52:55], s66 offen offset:0
    s_waitcnt lgkmcnt(4)
    v_pk_add_f32 v[112:113], v[112:113], v[132:133]
    v_pk_add_f32 v[114:115], v[114:115], v[134:135]
    v_pk_add_f32 v[116:117], v[116:117], v[136:137]
    v_pk_add_f32 v[118:119], v[118:119], v[138:139]
    v_pk_add_f32 v[152:153], v[152:153], v[172:173]
    v_pk_add_f32 v[154:155], v[154:155], v[174:175]
    v_pk_add_f32 v[156:157], v[156:157], v[176:177]
    v_pk_add_f32 v[158:159], v[158:159], v[178:179]
    v_pk_add_f32 v[112:113], v[112:113], v[92:93]
    v_pk_add_f32 v[114:115], v[114:115], v[94:95]
    v_pk_add_f32 v[116:117], v[116:117], v[96:97]
    v_pk_add_f32 v[118:119], v[118:119], v[98:99]
    v_pk_add_f32 v[112:113], v[112:113], v[152:153]
    v_pk_add_f32 v[114:115], v[114:115], v[154:155]
    v_pk_add_f32 v[116:117], v[116:117], v[156:157]
    v_pk_add_f32 v[118:119], v[118:119], v[158:159]
    v_pk_mul_f32 v[192:193], v[112:113], s[72:73]
    v_pk_mul_f32 v[194:195], v[114:115], s[72:73]
    v_pk_mul_f32 v[196:197], v[116:117], s[72:73]
    v_pk_mul_f32 v[198:199], v[118:119], s[72:73]
    v_exp_f32 v192, v192
    v_exp_f32 v193, v193
    v_exp_f32 v194, v194
    v_exp_f32 v195, v195
    v_exp_f32 v196, v196
    v_exp_f32 v197, v197
    v_exp_f32 v198, v198
    v_exp_f32 v199, v199
    v_pk_mul_f32 v[112:113], v[112:113], v[48:49]
    v_pk_mul_f32 v[114:115], v[114:115], v[50:51]
    v_pk_mul_f32 v[116:117], v[116:117], v[52:53]
    v_pk_mul_f32 v[118:119], v[118:119], v[54:55]
    v_pk_add_f32 v[192:193], v[192:193], 1.0 op_sel_hi:[1,0]
    v_pk_add_f32 v[194:195], v[194:195], 1.0 op_sel_hi:[1,0]
    v_pk_add_f32 v[196:197], v[196:197], 1.0 op_sel_hi:[1,0]
    v_pk_add_f32 v[198:199], v[198:199], 1.0 op_sel_hi:[1,0]
    v_rcp_f32 v192, v192
    v_rcp_f32 v193, v193
    v_rcp_f32 v194, v194
    v_rcp_f32 v195, v195
    v_rcp_f32 v196, v196
    v_rcp_f32 v197, v197
    v_rcp_f32 v198, v198
    v_rcp_f32 v199, v199
    v_pk_fma_f32 v[112:113], v[112:113], v[192:193], v[72:73]
    v_pk_fma_f32 v[114:115], v[114:115], v[194:195], v[74:75]
    v_pk_fma_f32 v[116:117], v[116:117], v[196:197], v[76:77]
    v_pk_fma_f32 v[118:119], v[118:119], v[198:199], v[78:79]
    v_cvt_pk_bf16_f32 v208, v112, v113
    v_cvt_pk_bf16_f32 v209, v114, v115
    v_cvt_pk_bf16_f32 v210, v116, v117
    v_cvt_pk_bf16_f32 v211, v118, v119
    buffer_store_dwordx4 v[208:211], v5, s[52:55], s66 offen offset:64
    s_waitcnt lgkmcnt(0)
    v_pk_add_f32 v[120:121], v[120:121], v[140:141]
    v_pk_add_f32 v[122:123], v[122:123], v[142:143]
    v_pk_add_f32 v[160:161], v[160:161], v[180:181]
    v_pk_add_f32 v[162:163], v[162:163], v[182:183]
    v_pk_add_f32 v[120:121], v[120:121], v[100:101]
    v_pk_add_f32 v[122:123], v[122:123], v[102:103]
    v_pk_add_f32 v[120:121], v[120:121], v[160:161]
    v_pk_add_f32 v[122:123], v[122:123], v[162:163]
    v_pk_mul_f32 v[200:201], v[120:121], s[72:73]
    v_pk_mul_f32 v[202:203], v[122:123], s[72:73]
    v_exp_f32 v200, v200
    v_exp_f32 v201, v201
    v_exp_f32 v202, v202
    v_exp_f32 v203, v203
    v_pk_mul_f32 v[120:121], v[120:121], v[56:57]
    v_pk_mul_f32 v[122:123], v[122:123], v[58:59]
    v_pk_add_f32 v[200:201], v[200:201], 1.0 op_sel_hi:[1,0]
    v_pk_add_f32 v[202:203], v[202:203], 1.0 op_sel_hi:[1,0]
    v_rcp_f32 v200, v200
    v_rcp_f32 v201, v201
    v_rcp_f32 v202, v202
    v_rcp_f32 v203, v203
    v_pk_fma_f32 v[120:121], v[120:121], v[200:201], v[80:81]
    v_pk_fma_f32 v[122:123], v[122:123], v[202:203], v[82:83]
    v_cvt_pk_bf16_f32 v212, v120, v121
    v_cvt_pk_bf16_f32 v213, v122, v123
    buffer_store_dwordx2 v[212:213], v4, s[52:55], s66 offen offset:128
    s_endpgm
L_helper:
    s_setprio 3
    s_lshl_b32 s62, s38, 2
    s_add_u32 s62, s62, s39
    s_mov_b32 s44, s4
    s_and_b32 s45, s5, 0xffff
    s_mov_b32 s46, 2621440
    s_mov_b32 s47, 0x20000
    v_lshrrev_b32 v10, 3, v1
    s_mul_i32 s64, s62, 81920
    s_lshl_b32 s65, s3, 8
    s_add_u32 s64, s64, s65
    s_lshl_b32 s66, s3, 14
    s_add_u32 s66, s66, 256
    s_add_u32 s65, s64, 0
    s_add_u32 m0, s66, 0
    s_nop 0
    buffer_load_dwordx4 v4, s[44:47], s65 offen offset:0 lds
    buffer_load_dwordx4 v5, s[44:47], s65 offen offset:1024 lds
    buffer_load_dwordx4 v6, s[44:47], s65 offen offset:2048 lds
    buffer_load_dwordx4 v7, s[44:47], s65 offen offset:3072 lds
    s_add_u32 s65, s64, 40960
    s_add_u32 m0, s66, 4096
    s_nop 0
    buffer_load_dwordx4 v4, s[44:47], s65 offen offset:0 lds
    buffer_load_dwordx4 v5, s[44:47], s65 offen offset:1024 lds
    buffer_load_dwordx4 v6, s[44:47], s65 offen offset:2048 lds
    buffer_load_dwordx4 v7, s[44:47], s65 offen offset:3072 lds
    s_add_u32 s65, s64, 128
    s_add_u32 m0, s66, 8192
    s_nop 0
    buffer_load_dwordx4 v4, s[44:47], s65 offen offset:0 lds
    buffer_load_dwordx4 v5, s[44:47], s65 offen offset:1024 lds
    buffer_load_dwordx4 v6, s[44:47], s65 offen offset:2048 lds
    buffer_load_dwordx4 v7, s[44:47], s65 offen offset:3072 lds
    s_add_u32 s65, s64, 41088
    s_add_u32 m0, s66, 12288
    s_nop 0
    buffer_load_dwordx4 v4, s[44:47], s65 offen offset:0 lds
    buffer_load_dwordx4 v5, s[44:47], s65 offen offset:1024 lds
    buffer_load_dwordx4 v6, s[44:47], s65 offen offset:2048 lds
    buffer_load_dwordx4 v7, s[44:47], s65 offen offset:3072 lds
    v_bfe_u32 v12, v1, 1, 3
    v_lshlrev_b32 v13, 7, v1
    v_lshl_add_u32 v13, v12, 4, v13
    v_add_u32 v13, s66, v13
    v_xor_b32 v16, 0, v13
    v_xor_b32 v17, 16, v13
    v_xor_b32 v18, 32, v13
    v_xor_b32 v19, 48, v13
    v_xor_b32 v20, 64, v13
    v_xor_b32 v21, 80, v13
    v_xor_b32 v22, 96, v13
    v_xor_b32 v23, 112, v13
    v_and_b32 v12, 7, v1
    v_and_b32 v14, 1, v12
    v_lshlrev_b32 v14, 2, v14
    v_xor_b32 v14, v14, v10
    v_lshlrev_b32 v15, 10, v12
    v_lshl_add_u32 v15, v14, 4, v15
    v_add_u32 v15, s66, v15
    v_xor_b32 v24, 0, v15
    v_xor_b32 v25, 16, v15
    v_xor_b32 v26, 32, v15
    v_xor_b32 v27, 48, v15
    s_mov_b32 s70, 0x3f803f80
    v_mov_b32 v32, 0
    v_mov_b32 v33, 0
    v_mov_b32 v34, 0
    v_mov_b32 v35, 0
    s_waitcnt vmcnt(8)
    ds_read_b128 v[40:43], v16 offset:0
    ds_read_b128 v[44:47], v17 offset:0
    ds_read_b128 v[48:51], v18 offset:0
    ds_read_b128 v[52:55], v19 offset:0
    ds_read_b128 v[56:59], v20 offset:0
    ds_read_b128 v[60:63], v21 offset:0
    ds_read_b128 v[64:67], v22 offset:0
    ds_read_b128 v[68:71], v23 offset:0
    s_waitcnt lgkmcnt(7)
    v_dot2_f32_bf16 v32, v40, s70, v32
    v_dot2_f32_bf16 v33, v40, v40, v33
    v_dot2_f32_bf16 v34, v41, s70, v34
    v_dot2_f32_bf16 v35, v41, v41, v35
    v_dot2_f32_bf16 v32, v42, s70, v32
    v_dot2_f32_bf16 v33, v42, v42, v33
    v_dot2_f32_bf16 v34, v43, s70, v34
    v_dot2_f32_bf16 v35, v43, v43, v35
    s_waitcnt lgkmcnt(6)
    v_dot2_f32_bf16 v32, v44, s70, v32
    v_dot2_f32_bf16 v33, v44, v44, v33
    v_dot2_f32_bf16 v34, v45, s70, v34
    v_dot2_f32_bf16 v35, v45, v45, v35
    v_dot2_f32_bf16 v32, v46, s70, v32
    v_dot2_f32_bf16 v33, v46, v46, v33
    v_dot2_f32_bf16 v34, v47, s70, v34
    v_dot2_f32_bf16 v35, v47, v47, v35
    s_waitcnt lgkmcnt(5)
    v_dot2_f32_bf16 v32, v48, s70, v32
    v_dot2_f32_bf16 v33, v48, v48, v33
    v_dot2_f32_bf16 v34, v49, s70, v34
    v_dot2_f32_bf16 v35, v49, v49, v35
    v_dot2_f32_bf16 v32, v50, s70, v32
    v_dot2_f32_bf16 v33, v50, v50, v33
    v_dot2_f32_bf16 v34, v51, s70, v34
    v_dot2_f32_bf16 v35, v51, v51, v35
    s_waitcnt lgkmcnt(4)
    v_dot2_f32_bf16 v32, v52, s70, v32
    v_dot2_f32_bf16 v33, v52, v52, v33
    v_dot2_f32_bf16 v34, v53, s70, v34
    v_dot2_f32_bf16 v35, v53, v53, v35
    v_dot2_f32_bf16 v32, v54, s70, v32
    v_dot2_f32_bf16 v33, v54, v54, v33
    v_dot2_f32_bf16 v34, v55, s70, v34
    v_dot2_f32_bf16 v35, v55, v55, v35
    s_waitcnt lgkmcnt(3)
    v_dot2_f32_bf16 v32, v56, s70, v32
    v_dot2_f32_bf16 v33, v56, v56, v33
    v_dot2_f32_bf16 v34, v57, s70, v34
    v_dot2_f32_bf16 v35, v57, v57, v35
    v_dot2_f32_bf16 v32, v58, s70, v32
    v_dot2_f32_bf16 v33, v58, v58, v33
    v_dot2_f32_bf16 v34, v59, s70, v34
    v_dot2_f32_bf16 v35, v59, v59, v35
    s_waitcnt lgkmcnt(2)
    v_dot2_f32_bf16 v32, v60, s70, v32
    v_dot2_f32_bf16 v33, v60, v60, v33
    v_dot2_f32_bf16 v34, v61, s70, v34
    v_dot2_f32_bf16 v35, v61, v61, v35
    v_dot2_f32_bf16 v32, v62, s70, v32
    v_dot2_f32_bf16 v33, v62, v62, v33
    v_dot2_f32_bf16 v34, v63, s70, v34
    v_dot2_f32_bf16 v35, v63, v63, v35
    s_waitcnt lgkmcnt(1)
    v_dot2_f32_bf16 v32, v64, s70, v32
    v_dot2_f32_bf16 v33, v64, v64, v33
    v_dot2_f32_bf16 v34, v65, s70, v34
    v_dot2_f32_bf16 v35, v65, v65, v35
    v_dot2_f32_bf16 v32, v66, s70, v32
    v_dot2_f32_bf16 v33, v66, v66, v33
    v_dot2_f32_bf16 v34, v67, s70, v34
    v_dot2_f32_bf16 v35, v67, v67, v35
    s_waitcnt lgkmcnt(0)
    v_dot2_f32_bf16 v32, v68, s70, v32
    v_dot2_f32_bf16 v33, v68, v68, v33
    v_dot2_f32_bf16 v34, v69, s70, v34
    v_dot2_f32_bf16 v35, v69, v69, v35
    v_dot2_f32_bf16 v32, v70, s70, v32
    v_dot2_f32_bf16 v33, v70, v70, v33
    v_dot2_f32_bf16 v34, v71, s70, v34
    v_dot2_f32_bf16 v35, v71, v71, v35
    s_waitcnt vmcnt(0)
    ds_read_b128 v[40:43], v16 offset:8192
    ds_read_b128 v[44:47], v17 offset:8192
    ds_read_b128 v[48:51], v18 offset:8192
    ds_read_b128 v[52:55], v19 offset:8192
    ds_read_b128 v[56:59], v20 offset:8192
    ds_read_b128 v[60:63], v21 offset:8192
    ds_read_b128 v[64:67], v22 offset:8192
    ds_read_b128 v[68:71], v23 offset:8192
    s_waitcnt lgkmcnt(7)
    v_dot2_f32_bf16 v32, v40, s70, v32
    v_dot2_f32_bf16 v33, v40, v40, v33
    v_dot2_f32_bf16 v34, v41, s70, v34
    v_dot2_f32_bf16 v35, v41, v41, v35
    v_dot2_f32_bf16 v32, v42, s70, v32
    v_dot2_f32_bf16 v33, v42, v42, v33
    v_dot2_f32_bf16 v34, v43, s70, v34
    v_dot2_f32_bf16 v35, v43, v43, v35
    s_waitcnt lgkmcnt(6)
    v_dot2_f32_bf16 v32, v44, s70, v32
    v_dot2_f32_bf16 v33, v44, v44, v33
    v_dot2_f32_bf16 v34, v45, s70, v34
    v_dot2_f32_bf16 v35, v45, v45, v35
    v_dot2_f32_bf16 v32, v46, s70, v32
    v_dot2_f32_bf16 v33, v46, v46, v33
    v_dot2_f32_bf16 v34, v47, s70, v34
    v_dot2_f32_bf16 v35, v47, v47, v35
    s_waitcnt lgkmcnt(5)
    v_dot2_f32_bf16 v32, v48, s70, v32
    v_dot2_f32_bf16 v33, v48, v48, v33
    v_dot2_f32_bf16 v34, v49, s70, v34
    v_dot2_f32_bf16 v35, v49, v49, v35
    v_dot2_f32_bf16 v32, v50, s70, v32
    v_dot2_f32_bf16 v33, v50, v50, v33
    v_dot2_f32_bf16 v34, v51, s70, v34
    v_dot2_f32_bf16 v35, v51, v51, v35
    s_waitcnt lgkmcnt(4)
    v_dot2_f32_bf16 v32, v52, s70, v32
    v_dot2_f32_bf16 v33, v52, v52, v33
    v_dot2_f32_bf16 v34, v53, s70, v34
    v_dot2_f32_bf16 v35, v53, v53, v35
    v_dot2_f32_bf16 v32, v54, s70, v32
    v_dot2_f32_bf16 v33, v54, v54, v33
    v_dot2_f32_bf16 v34, v55, s70, v34
    v_dot2_f32_bf16 v35, v55, v55, v35
    s_waitcnt lgkmcnt(3)
    v_dot2_f32_bf16 v32, v56, s70, v32
    v_dot2_f32_bf16 v33, v56, v56, v33
    v_dot2_f32_bf16 v34, v57, s70, v34
    v_dot2_f32_bf16 v35, v57, v57, v35
    v_dot2_f32_bf16 v32, v58, s70, v32
    v_dot2_f32_bf16 v33, v58, v58, v33
    v_dot2_f32_bf16 v34, v59, s70, v34
    v_dot2_f32_bf16 v35, v59, v59, v35
    s_waitcnt lgkmcnt(2)
    v_dot2_f32_bf16 v32, v60, s70, v32
    v_dot2_f32_bf16 v33, v60, v60, v33
    v_dot2_f32_bf16 v34, v61, s70, v34
    v_dot2_f32_bf16 v35, v61, v61, v35
    v_dot2_f32_bf16 v32, v62, s70, v32
    v_dot2_f32_bf16 v33, v62, v62, v33
    v_dot2_f32_bf16 v34, v63, s70, v34
    v_dot2_f32_bf16 v35, v63, v63, v35
    s_waitcnt lgkmcnt(1)
    v_dot2_f32_bf16 v32, v64, s70, v32
    v_dot2_f32_bf16 v33, v64, v64, v33
    v_dot2_f32_bf16 v34, v65, s70, v34
    v_dot2_f32_bf16 v35, v65, v65, v35
    v_dot2_f32_bf16 v32, v66, s70, v32
    v_dot2_f32_bf16 v33, v66, v66, v33
    v_dot2_f32_bf16 v34, v67, s70, v34
    v_dot2_f32_bf16 v35, v67, v67, v35
    s_waitcnt lgkmcnt(0)
    v_dot2_f32_bf16 v32, v68, s70, v32
    v_dot2_f32_bf16 v33, v68, v68, v33
    v_dot2_f32_bf16 v34, v69, s70, v34
    v_dot2_f32_bf16 v35, v69, v69, v35
    v_dot2_f32_bf16 v32, v70, s70, v32
    v_dot2_f32_bf16 v33, v70, v70, v33
    v_dot2_f32_bf16 v34, v71, s70, v34
    v_dot2_f32_bf16 v35, v71, v71, v35
    s_nop 2
    v_pk_add_f32 v[32:33], v[32:33], v[34:35]
    s_lshl_b32 s67, s3, 9
    v_lshlrev_b32 v36, 3, v1
    v_add_u32 v37, s67, v36
    v_add_u32 v37, 82176, v37
    ds_write_b64 v37, v[32:33]
    s_lshl_b32 s68, s3, 2
    s_add_u32 s68, s68, 64
    v_mov_b32 v38, s68
    v_mov_b32 v39, 1
    s_mov_b64 exec, 1
    ds_write_b32 v38, v39
    s_mov_b64 exec, -1
    ds_read_b128 v[72:75], v24 offset:0
    ds_read_b128 v[76:79], v24 offset:128
    ds_read_b128 v[80:83], v25 offset:256
    ds_read_b128 v[84:87], v25 offset:384
    ds_read_b128 v[88:91], v26 offset:512
    ds_read_b128 v[92:95], v26 offset:640
    ds_read_b128 v[96:99], v27 offset:768
    ds_read_b128 v[100:103], v27 offset:896
    ds_read_b128 v[104:107], v24 offset:8192
    ds_read_b128 v[108:111], v24 offset:8320
    ds_read_b128 v[112:115], v25 offset:8448
    ds_read_b128 v[116:119], v25 offset:8576
    ds_read_b128 v[120:123], v26 offset:8704
    ds_read_b128 v[124:127], v26 offset:8832
    ds_read_b128 v[128:131], v27 offset:8960
    ds_read_b128 v[132:135], v27 offset:9088
    v_min_u32 v38, 4, v1
    v_lshlrev_b32 v38, 2, v38
    v_add_u32 v38, 64, v38
    s_mov_b32 s77, 0
L_lw26:
    ds_read_b32 v39, v38
    s_waitcnt lgkmcnt(0)
    v_cmp_ne_u32 vcc, 0, v39
    s_nop 0
    s_cmp_eq_u64 vcc, -1
    s_cbranch_scc1 L_lx26
    s_add_u32 s77, s77, 1
    s_cmp_ge_u32 s77, 160000
    s_cbranch_scc1 L_lx26
    s_branch L_lw26
L_lx26:
    v_add_u32 v38, 82176, v36
    ds_read_b64 v[40:41], v38 offset:0
    ds_read_b64 v[42:43], v38 offset:512
    ds_read_b64 v[44:45], v38 offset:1024
    ds_read_b64 v[46:47], v38 offset:1536
    ds_read_b64 v[48:49], v38 offset:2048
    s_waitcnt lgkmcnt(0)
    v_pk_add_f32 v[40:41], v[40:41], v[42:43]
    v_pk_add_f32 v[44:45], v[44:45], v[46:47]
    v_pk_add_f32 v[40:41], v[40:41], v[48:49]
    v_pk_add_f32 v[40:41], v[40:41], v[44:45]
    v_mul_f32 v40, 0x3acccccd, v40
    v_mul_f32 v41, 0x3acccccd, v41
    v_fma_f32 v41, -v40, v40, v41
    v_max_f32 v41, 0, v41
    v_cvt_pk_bf16_f32 v42, v40, v41
    v_lshlrev_b32 v40, 16, v42
    v_and_b32 v41, 0xffff0000, v42
    v_add_f32 v41, 0x3727c5ac, v41
    v_cvt_pk_bf16_f32 v41, v41, v41
    v_lshlrev_b32 v41, 16, v41
    v_sqrt_f32 v41, v41
    s_nop 0
    v_cvt_pk_bf16_f32 v45, v41, 0
    v_lshlrev_b32 v41, 16, v45
    v_rcp_f32 v46, v41
    v_cvt_pk_bf16_f32 v44, -v40, v41
    v_mul_f32 v47, -v40, v46
    v_add_u32 v37, 2560, v37
    ds_write_b64 v37, v[46:47]
    s_cmp_lg_u32 s3, 1
    s_cbranch_scc1 L_ln_nopub
    v_mov_b32 v42, 32
    s_mov_b32 s77, 0
L_lw27:
    ds_read_b32 v45, v42
    s_waitcnt lgkmcnt(0)
    v_cmp_ne_u32 vcc, 0, v45
    s_nop 0
    s_cmp_eq_u64 vcc, -1
    s_cbranch_scc1 L_lx27
    s_add_u32 s77, s77, 1
    s_cmp_ge_u32 s77, 160000
    s_cbranch_scc1 L_lx27
    s_sleep 1
    s_branch L_lw27
L_lx27:
    v_readfirstlane_b32 s59, v45
    s_lshl_b32 s68, s62, 9
    s_add_u32 s68, s68, 15056896
    buffer_store_dwordx2 v[44:45], v36, s[40:43], s68 offen sc1
L_ln_nopub:
    s_setprio 1
    v_lshlrev_b32 v38, 6, v12
    v_add_u32 v38, s67, v38
    v_add_u32 v38, 84736, v38
    ds_read_b128 v[48:51], v38 offset:0
    ds_read_b128 v[52:55], v38 offset:16
    ds_read_b128 v[56:59], v38 offset:32
    ds_read_b128 v[60:63], v38 offset:48
    v_mul_u32_u24 v39, 1024, v10
    v_lshl_add_u32 v39, v12, 4, v39
    s_mul_i32 s68, s3, 16384
    s_mul_i32 s69, s62, 82048
    s_add_u32 s68, s68, s69
    s_waitcnt lgkmcnt(0)
    v_lshlrev_b32 v136, 16, v72
    v_and_b32 v137, 0xffff0000, v72
    v_lshlrev_b32 v138, 16, v76
    v_and_b32 v139, 0xffff0000, v76
    v_lshlrev_b32 v140, 16, v80
    v_and_b32 v141, 0xffff0000, v80
    v_lshlrev_b32 v142, 16, v84
    v_and_b32 v143, 0xffff0000, v84
    v_lshlrev_b32 v144, 16, v88
    v_and_b32 v145, 0xffff0000, v88
    v_lshlrev_b32 v146, 16, v92
    v_and_b32 v147, 0xffff0000, v92
    v_lshlrev_b32 v148, 16, v96
    v_and_b32 v149, 0xffff0000, v96
    v_lshlrev_b32 v150, 16, v100
    v_and_b32 v151, 0xffff0000, v100
    v_pk_fma_f32 v[136:137], v[136:137], v[48:49], v[48:49] op_sel:[0,0,1] op_sel_hi:[1,0,1]
    v_pk_fma_f32 v[138:139], v[138:139], v[50:51], v[50:51] op_sel:[0,0,1] op_sel_hi:[1,0,1]
    v_pk_fma_f32 v[140:141], v[140:141], v[52:53], v[52:53] op_sel:[0,0,1] op_sel_hi:[1,0,1]
    v_pk_fma_f32 v[142:143], v[142:143], v[54:55], v[54:55] op_sel:[0,0,1] op_sel_hi:[1,0,1]
    v_pk_fma_f32 v[144:145], v[144:145], v[56:57], v[56:57] op_sel:[0,0,1] op_sel_hi:[1,0,1]
    v_pk_fma_f32 v[146:147], v[146:147], v[58:59], v[58:59] op_sel:[0,0,1] op_sel_hi:[1,0,1]
    v_pk_fma_f32 v[148:149], v[148:149], v[60:61], v[60:61] op_sel:[0,0,1] op_sel_hi:[1,0,1]
    v_pk_fma_f32 v[150:151], v[150:151], v[62:63], v[62:63] op_sel:[0,0,1] op_sel_hi:[1,0,1]
    v_cvt_pk_bf16_f32 v168, v136, v138
    v_cvt_pk_bf16_f32 v169, v140, v142
    v_cvt_pk_bf16_f32 v170, v144, v146
    v_cvt_pk_bf16_f32 v171, v148, v150
    s_add_u32 s69, s68, 0
    buffer_store_dwordx4 v[168:171], v39, s[40:43], s69 offen sc1
    v_cvt_pk_bf16_f32 v172, v137, v139
    v_cvt_pk_bf16_f32 v173, v141, v143
    v_cvt_pk_bf16_f32 v174, v145, v147
    v_cvt_pk_bf16_f32 v175, v149, v151
    s_add_u32 s69, s68, 128
    buffer_store_dwordx4 v[172:175], v39, s[40:43], s69 offen sc1
    v_lshlrev_b32 v152, 16, v73
    v_and_b32 v153, 0xffff0000, v73
    v_lshlrev_b32 v154, 16, v77
    v_and_b32 v155, 0xffff0000, v77
    v_lshlrev_b32 v156, 16, v81
    v_and_b32 v157, 0xffff0000, v81
    v_lshlrev_b32 v158, 16, v85
    v_and_b32 v159, 0xffff0000, v85
    v_lshlrev_b32 v160, 16, v89
    v_and_b32 v161, 0xffff0000, v89
    v_lshlrev_b32 v162, 16, v93
    v_and_b32 v163, 0xffff0000, v93
    v_lshlrev_b32 v164, 16, v97
    v_and_b32 v165, 0xffff0000, v97
    v_lshlrev_b32 v166, 16, v101
    v_and_b32 v167, 0xffff0000, v101
    v_pk_fma_f32 v[152:153], v[152:153], v[48:49], v[48:49] op_sel:[0,0,1] op_sel_hi:[1,0,1]
    v_pk_fma_f32 v[154:155], v[154:155], v[50:51], v[50:51] op_sel:[0,0,1] op_sel_hi:[1,0,1]
    v_pk_fma_f32 v[156:157], v[156:157], v[52:53], v[52:53] op_sel:[0,0,1] op_sel_hi:[1,0,1]
    v_pk_fma_f32 v[158:159], v[158:159], v[54:55], v[54:55] op_sel:[0,0,1] op_sel_hi:[1,0,1]
    v_pk_fma_f32 v[160:161], v[160:161], v[56:57], v[56:57] op_sel:[0,0,1] op_sel_hi:[1,0,1]
    v_pk_fma_f32 v[162:163], v[162:163], v[58:59], v[58:59] op_sel:[0,0,1] op_sel_hi:[1,0,1]
    v_pk_fma_f32 v[164:165], v[164:165], v[60:61], v[60:61] op_sel:[0,0,1] op_sel_hi:[1,0,1]
    v_pk_fma_f32 v[166:167], v[166:167], v[62:63], v[62:63] op_sel:[0,0,1] op_sel_hi:[1,0,1]
    v_cvt_pk_bf16_f32 v176, v152, v154
    v_cvt_pk_bf16_f32 v177, v156, v158
    v_cvt_pk_bf16_f32 v178, v160, v162
    v_cvt_pk_bf16_f32 v179, v164, v166
    s_add_u32 s69, s68, 256
    buffer_store_dwordx4 v[176:179], v39, s[40:43], s69 offen sc1
    v_cvt_pk_bf16_f32 v180, v153, v155
    v_cvt_pk_bf16_f32 v181, v157, v159
    v_cvt_pk_bf16_f32 v182, v161, v163
    v_cvt_pk_bf16_f32 v183, v165, v167
    s_add_u32 s69, s68, 384
    buffer_store_dwordx4 v[180:183], v39, s[40:43], s69 offen sc1
    v_lshlrev_b32 v136, 16, v74
    v_and_b32 v137, 0xffff0000, v74
    v_lshlrev_b32 v138, 16, v78
    v_and_b32 v139, 0xffff0000, v78
    v_lshlrev_b32 v140, 16, v82
    v_and_b32 v141, 0xffff0000, v82
    v_lshlrev_b32 v142, 16, v86
    v_and_b32 v143, 0xffff0000, v86
    v_lshlrev_b32 v144, 16, v90
    v_and_b32 v145, 0xffff0000, v90
    v_lshlrev_b32 v146, 16, v94
    v_and_b32 v147, 0xffff0000, v94
    v_lshlrev_b32 v148, 16, v98
    v_and_b32 v149, 0xffff0000, v98
    v_lshlrev_b32 v150, 16, v102
    v_and_b32 v151, 0xffff0000, v102
    v_pk_fma_f32 v[136:137], v[136:137], v[48:49], v[48:49] op_sel:[0,0,1] op_sel_hi:[1,0,1]
    v_pk_fma_f32 v[138:139], v[138:139], v[50:51], v[50:51] op_sel:[0,0,1] op_sel_hi:[1,0,1]
    v_pk_fma_f32 v[140:141], v[140:141], v[52:53], v[52:53] op_sel:[0,0,1] op_sel_hi:[1,0,1]
    v_pk_fma_f32 v[142:143], v[142:143], v[54:55], v[54:55] op_sel:[0,0,1] op_sel_hi:[1,0,1]
    v_pk_fma_f32 v[144:145], v[144:145], v[56:57], v[56:57] op_sel:[0,0,1] op_sel_hi:[1,0,1]
    v_pk_fma_f32 v[146:147], v[146:147], v[58:59], v[58:59] op_sel:[0,0,1] op_sel_hi:[1,0,1]
    v_pk_fma_f32 v[148:149], v[148:149], v[60:61], v[60:61] op_sel:[0,0,1] op_sel_hi:[1,0,1]
    v_pk_fma_f32 v[150:151], v[150:151], v[62:63], v[62:63] op_sel:[0,0,1] op_sel_hi:[1,0,1]
    v_cvt_pk_bf16_f32 v168, v136, v138
    v_cvt_pk_bf16_f32 v169, v140, v142
    v_cvt_pk_bf16_f32 v170, v144, v146
    v_cvt_pk_bf16_f32 v171, v148, v150
    s_add_u32 s69, s68, 512
    buffer_store_dwordx4 v[168:171], v39, s[40:43], s69 offen sc1
    v_cvt_pk_bf16_f32 v172, v137, v139
    v_cvt_pk_bf16_f32 v173, v141, v143
    v_cvt_pk_bf16_f32 v174, v145, v147
    v_cvt_pk_bf16_f32 v175, v149, v151
    s_add_u32 s69, s68, 640
    buffer_store_dwordx4 v[172:175], v39, s[40:43], s69 offen sc1
    v_lshlrev_b32 v152, 16, v75
    v_and_b32 v153, 0xffff0000, v75
    v_lshlrev_b32 v154, 16, v79
    v_and_b32 v155, 0xffff0000, v79
    v_lshlrev_b32 v156, 16, v83
    v_and_b32 v157, 0xffff0000, v83
    v_lshlrev_b32 v158, 16, v87
    v_and_b32 v159, 0xffff0000, v87
    v_lshlrev_b32 v160, 16, v91
    v_and_b32 v161, 0xffff0000, v91
    v_lshlrev_b32 v162, 16, v95
    v_and_b32 v163, 0xffff0000, v95
    v_lshlrev_b32 v164, 16, v99
    v_and_b32 v165, 0xffff0000, v99
    v_lshlrev_b32 v166, 16, v103
    v_and_b32 v167, 0xffff0000, v103
    v_pk_fma_f32 v[152:153], v[152:153], v[48:49], v[48:49] op_sel:[0,0,1] op_sel_hi:[1,0,1]
    v_pk_fma_f32 v[154:155], v[154:155], v[50:51], v[50:51] op_sel:[0,0,1] op_sel_hi:[1,0,1]
    v_pk_fma_f32 v[156:157], v[156:157], v[52:53], v[52:53] op_sel:[0,0,1] op_sel_hi:[1,0,1]
    v_pk_fma_f32 v[158:159], v[158:159], v[54:55], v[54:55] op_sel:[0,0,1] op_sel_hi:[1,0,1]
    v_pk_fma_f32 v[160:161], v[160:161], v[56:57], v[56:57] op_sel:[0,0,1] op_sel_hi:[1,0,1]
    v_pk_fma_f32 v[162:163], v[162:163], v[58:59], v[58:59] op_sel:[0,0,1] op_sel_hi:[1,0,1]
    v_pk_fma_f32 v[164:165], v[164:165], v[60:61], v[60:61] op_sel:[0,0,1] op_sel_hi:[1,0,1]
    v_pk_fma_f32 v[166:167], v[166:167], v[62:63], v[62:63] op_sel:[0,0,1] op_sel_hi:[1,0,1]
    v_cvt_pk_bf16_f32 v176, v152, v154
    v_cvt_pk_bf16_f32 v177, v156, v158
    v_cvt_pk_bf16_f32 v178, v160, v162
    v_cvt_pk_bf16_f32 v179, v164, v166
    s_add_u32 s69, s68, 768
    buffer_store_dwordx4 v[176:179], v39, s[40:43], s69 offen sc1
    v_cvt_pk_bf16_f32 v180, v153, v155
    v_cvt_pk_bf16_f32 v181, v157, v159
    v_cvt_pk_bf16_f32 v182, v161, v163
    v_cvt_pk_bf16_f32 v183, v165, v167
    s_add_u32 s69, s68, 896
    buffer_store_dwordx4 v[180:183], v39, s[40:43], s69 offen sc1
    v_lshlrev_b32 v136, 16, v104
    v_and_b32 v137, 0xffff0000, v104
    v_lshlrev_b32 v138, 16, v108
    v_and_b32 v139, 0xffff0000, v108
    v_lshlrev_b32 v140, 16, v112
    v_and_b32 v141, 0xffff0000, v112
    v_lshlrev_b32 v142, 16, v116
    v_and_b32 v143, 0xffff0000, v116
    v_lshlrev_b32 v144, 16, v120
    v_and_b32 v145, 0xffff0000, v120
    v_lshlrev_b32 v146, 16, v124
    v_and_b32 v147, 0xffff0000, v124
    v_lshlrev_b32 v148, 16, v128
    v_and_b32 v149, 0xffff0000, v128
    v_lshlrev_b32 v150, 16, v132
    v_and_b32 v151, 0xffff0000, v132
    v_pk_fma_f32 v[136:137], v[136:137], v[48:49], v[48:49] op_sel:[0,0,1] op_sel_hi:[1,0,1]
    v_pk_fma_f32 v[138:139], v[138:139], v[50:51], v[50:51] op_sel:[0,0,1] op_sel_hi:[1,0,1]
    v_pk_fma_f32 v[140:141], v[140:141], v[52:53], v[52:53] op_sel:[0,0,1] op_sel_hi:[1,0,1]
    v_pk_fma_f32 v[142:143], v[142:143], v[54:55], v[54:55] op_sel:[0,0,1] op_sel_hi:[1,0,1]
    v_pk_fma_f32 v[144:145], v[144:145], v[56:57], v[56:57] op_sel:[0,0,1] op_sel_hi:[1,0,1]
    v_pk_fma_f32 v[146:147], v[146:147], v[58:59], v[58:59] op_sel:[0,0,1] op_sel_hi:[1,0,1]
    v_pk_fma_f32 v[148:149], v[148:149], v[60:61], v[60:61] op_sel:[0,0,1] op_sel_hi:[1,0,1]
    v_pk_fma_f32 v[150:151], v[150:151], v[62:63], v[62:63] op_sel:[0,0,1] op_sel_hi:[1,0,1]
    v_cvt_pk_bf16_f32 v168, v136, v138
    v_cvt_pk_bf16_f32 v169, v140, v142
    v_cvt_pk_bf16_f32 v170, v144, v146
    v_cvt_pk_bf16_f32 v171, v148, v150
    s_add_u32 s69, s68, 8192
    buffer_store_dwordx4 v[168:171], v39, s[40:43], s69 offen sc1
    v_cvt_pk_bf16_f32 v172, v137, v139
    v_cvt_pk_bf16_f32 v173, v141, v143
    v_cvt_pk_bf16_f32 v174, v145, v147
    v_cvt_pk_bf16_f32 v175, v149, v151
    s_add_u32 s69, s68, 8320
    buffer_store_dwordx4 v[172:175], v39, s[40:43], s69 offen sc1
    v_lshlrev_b32 v152, 16, v105
    v_and_b32 v153, 0xffff0000, v105
    v_lshlrev_b32 v154, 16, v109
    v_and_b32 v155, 0xffff0000, v109
    v_lshlrev_b32 v156, 16, v113
    v_and_b32 v157, 0xffff0000, v113
    v_lshlrev_b32 v158, 16, v117
    v_and_b32 v159, 0xffff0000, v117
    v_lshlrev_b32 v160, 16, v121
    v_and_b32 v161, 0xffff0000, v121
    v_lshlrev_b32 v162, 16, v125
    v_and_b32 v163, 0xffff0000, v125
    v_lshlrev_b32 v164, 16, v129
    v_and_b32 v165, 0xffff0000, v129
    v_lshlrev_b32 v166, 16, v133
    v_and_b32 v167, 0xffff0000, v133
    v_pk_fma_f32 v[152:153], v[152:153], v[48:49], v[48:49] op_sel:[0,0,1] op_sel_hi:[1,0,1]
    v_pk_fma_f32 v[154:155], v[154:155], v[50:51], v[50:51] op_sel:[0,0,1] op_sel_hi:[1,0,1]
    v_pk_fma_f32 v[156:157], v[156:157], v[52:53], v[52:53] op_sel:[0,0,1] op_sel_hi:[1,0,1]
    v_pk_fma_f32 v[158:159], v[158:159], v[54:55], v[54:55] op_sel:[0,0,1] op_sel_hi:[1,0,1]
    v_pk_fma_f32 v[160:161], v[160:161], v[56:57], v[56:57] op_sel:[0,0,1] op_sel_hi:[1,0,1]
    v_pk_fma_f32 v[162:163], v[162:163], v[58:59], v[58:59] op_sel:[0,0,1] op_sel_hi:[1,0,1]
    v_pk_fma_f32 v[164:165], v[164:165], v[60:61], v[60:61] op_sel:[0,0,1] op_sel_hi:[1,0,1]
    v_pk_fma_f32 v[166:167], v[166:167], v[62:63], v[62:63] op_sel:[0,0,1] op_sel_hi:[1,0,1]
    v_cvt_pk_bf16_f32 v176, v152, v154
    v_cvt_pk_bf16_f32 v177, v156, v158
    v_cvt_pk_bf16_f32 v178, v160, v162
    v_cvt_pk_bf16_f32 v179, v164, v166
    s_add_u32 s69, s68, 8448
    buffer_store_dwordx4 v[176:179], v39, s[40:43], s69 offen sc1
    v_cvt_pk_bf16_f32 v180, v153, v155
    v_cvt_pk_bf16_f32 v181, v157, v159
    v_cvt_pk_bf16_f32 v182, v161, v163
    v_cvt_pk_bf16_f32 v183, v165, v167
    s_add_u32 s69, s68, 8576
    buffer_store_dwordx4 v[180:183], v39, s[40:43], s69 offen sc1
    v_lshlrev_b32 v136, 16, v106
    v_and_b32 v137, 0xffff0000, v106
    v_lshlrev_b32 v138, 16, v110
    v_and_b32 v139, 0xffff0000, v110
    v_lshlrev_b32 v140, 16, v114
    v_and_b32 v141, 0xffff0000, v114
    v_lshlrev_b32 v142, 16, v118
    v_and_b32 v143, 0xffff0000, v118
    v_lshlrev_b32 v144, 16, v122
    v_and_b32 v145, 0xffff0000, v122
    v_lshlrev_b32 v146, 16, v126
    v_and_b32 v147, 0xffff0000, v126
    v_lshlrev_b32 v148, 16, v130
    v_and_b32 v149, 0xffff0000, v130
    v_lshlrev_b32 v150, 16, v134
    v_and_b32 v151, 0xffff0000, v134
    v_pk_fma_f32 v[136:137], v[136:137], v[48:49], v[48:49] op_sel:[0,0,1] op_sel_hi:[1,0,1]
    v_pk_fma_f32 v[138:139], v[138:139], v[50:51], v[50:51] op_sel:[0,0,1] op_sel_hi:[1,0,1]
    v_pk_fma_f32 v[140:141], v[140:141], v[52:53], v[52:53] op_sel:[0,0,1] op_sel_hi:[1,0,1]
    v_pk_fma_f32 v[142:143], v[142:143], v[54:55], v[54:55] op_sel:[0,0,1] op_sel_hi:[1,0,1]
    v_pk_fma_f32 v[144:145], v[144:145], v[56:57], v[56:57] op_sel:[0,0,1] op_sel_hi:[1,0,1]
    v_pk_fma_f32 v[146:147], v[146:147], v[58:59], v[58:59] op_sel:[0,0,1] op_sel_hi:[1,0,1]
    v_pk_fma_f32 v[148:149], v[148:149], v[60:61], v[60:61] op_sel:[0,0,1] op_sel_hi:[1,0,1]
    v_pk_fma_f32 v[150:151], v[150:151], v[62:63], v[62:63] op_sel:[0,0,1] op_sel_hi:[1,0,1]
    v_cvt_pk_bf16_f32 v168, v136, v138
    v_cvt_pk_bf16_f32 v169, v140, v142
    v_cvt_pk_bf16_f32 v170, v144, v146
    v_cvt_pk_bf16_f32 v171, v148, v150
    s_add_u32 s69, s68, 8704
    buffer_store_dwordx4 v[168:171], v39, s[40:43], s69 offen sc1
    v_cvt_pk_bf16_f32 v172, v137, v139
    v_cvt_pk_bf16_f32 v173, v141, v143
    v_cvt_pk_bf16_f32 v174, v145, v147
    v_cvt_pk_bf16_f32 v175, v149, v151
    s_add_u32 s69, s68, 8832
    buffer_store_dwordx4 v[172:175], v39, s[40:43], s69 offen sc1
    v_lshlrev_b32 v152, 16, v107
    v_and_b32 v153, 0xffff0000, v107
    v_lshlrev_b32 v154, 16, v111
    v_and_b32 v155, 0xffff0000, v111
    v_lshlrev_b32 v156, 16, v115
    v_and_b32 v157, 0xffff0000, v115
    v_lshlrev_b32 v158, 16, v119
    v_and_b32 v159, 0xffff0000, v119
    v_lshlrev_b32 v160, 16, v123
    v_and_b32 v161, 0xffff0000, v123
    v_lshlrev_b32 v162, 16, v127
    v_and_b32 v163, 0xffff0000, v127
    v_lshlrev_b32 v164, 16, v131
    v_and_b32 v165, 0xffff0000, v131
    v_lshlrev_b32 v166, 16, v135
    v_and_b32 v167, 0xffff0000, v135
    v_pk_fma_f32 v[152:153], v[152:153], v[48:49], v[48:49] op_sel:[0,0,1] op_sel_hi:[1,0,1]
    v_pk_fma_f32 v[154:155], v[154:155], v[50:51], v[50:51] op_sel:[0,0,1] op_sel_hi:[1,0,1]
    v_pk_fma_f32 v[156:157], v[156:157], v[52:53], v[52:53] op_sel:[0,0,1] op_sel_hi:[1,0,1]
    v_pk_fma_f32 v[158:159], v[158:159], v[54:55], v[54:55] op_sel:[0,0,1] op_sel_hi:[1,0,1]
    v_pk_fma_f32 v[160:161], v[160:161], v[56:57], v[56:57] op_sel:[0,0,1] op_sel_hi:[1,0,1]
    v_pk_fma_f32 v[162:163], v[162:163], v[58:59], v[58:59] op_sel:[0,0,1] op_sel_hi:[1,0,1]
    v_pk_fma_f32 v[164:165], v[164:165], v[60:61], v[60:61] op_sel:[0,0,1] op_sel_hi:[1,0,1]
    v_pk_fma_f32 v[166:167], v[166:167], v[62:63], v[62:63] op_sel:[0,0,1] op_sel_hi:[1,0,1]
    v_cvt_pk_bf16_f32 v176, v152, v154
    v_cvt_pk_bf16_f32 v177, v156, v158
    v_cvt_pk_bf16_f32 v178, v160, v162
    v_cvt_pk_bf16_f32 v179, v164, v166
    s_add_u32 s69, s68, 8960
    buffer_store_dwordx4 v[176:179], v39, s[40:43], s69 offen sc1
    v_cvt_pk_bf16_f32 v180, v153, v155
    v_cvt_pk_bf16_f32 v181, v157, v159
    v_cvt_pk_bf16_f32 v182, v161, v163
    v_cvt_pk_bf16_f32 v183, v165, v167
    s_add_u32 s69, s68, 9088
    buffer_store_dwordx4 v[180:183], v39, s[40:43], s69 offen sc1
    v_mov_b32 v40, 32
    s_mov_b32 s77, 0
L_lw28:
    ds_read_b32 v41, v40
    s_waitcnt lgkmcnt(0)
    v_cmp_ne_u32 vcc, 0, v41
    s_nop 0
    s_cmp_eq_u64 vcc, -1
    s_cbranch_scc1 L_lx28
    s_add_u32 s77, s77, 1
    s_cmp_ge_u32 s77, 160000
    s_cbranch_scc1 L_lx28
    s_sleep 1
    s_branch L_lw28
L_lx28:
    v_readfirstlane_b32 s59, v41
    s_lshl_b32 s68, s3, 5
    s_add_u32 s68, s68, s62
    s_lshl_b32 s68, s68, 7
    s_add_u32 s68, s68, 15106048
    s_waitcnt vmcnt(0)
    v_lshlrev_b32 v40, 2, v1
    v_mov_b32 v41, s59
    s_mov_b32 exec_hi, 0
    buffer_store_dword v41, v40, s[40:43], s68 offen sc1
    s_mov_b64 exec, -1
    s_cmp_lg_u32 s3, 4
    s_cbranch_scc1 L_helper_g
    s_mov_b32 s52, s34
    s_and_b32 s53, s35, 0xffff
    s_mov_b32 s54, 256
    s_mov_b32 s55, 0x20000
    v_lshlrev_b32 v30, 4, v1
    v_lshlrev_b32 v32, 2, v1
    s_lshr_b32 s72, s58, 7
    s_add_u32 s73, s58, 4
    s_lshr_b32 s73, s73, 7
    s_sub_u32 s73, s73, s72
    s_cmp_eq_u32 s73, 0
    s_cselect_b32 s73, 0x7f, -1
    v_and_b32 v33, s73, v32
    v_lshlrev_b32 v33, 5, v33
    s_lshl_b32 s72, s72, 12
    s_add_u32 s72, s72, 15106048
    v_mov_b32 v35, 0
    v_and_b32 v20, 3, v1
    v_lshlrev_b32 v20, 2, v20
    v_add_u32 v20, 16, v20
    buffer_load_dword v36, v35, s[52:55], 0 offen offset:252 sc1
    s_lshl_b32 s73, s60, 10
    s_add_u32 s73, s73, 15056896
    buffer_load_dwordx4 v[40:43], v30, s[40:43], s73 offen sc1
    s_mov_b32 s75, 0
    s_waitcnt vmcnt(0)
    s_branch L_ld_rec
L_helper_g:
    v_lshlrev_b32 v2, 4, v1
    v_add_u32 v3, 4096, v2
    s_mul_i32 s72, s57, 54
    s_mul_i32 s73, s3, 14
    s_add_u32 s72, s72, s73
    s_mul_i32 s72, s72, 5120
    s_add_u32 s72, s72, 12845056
    s_lshl_b32 s75, s3, 2
    s_add_u32 s75, s75, 16
    s_cmp_eq_u32 s3, 3
    s_cselect_b32 s49, 0x70000000, 0
    s_cselect_b32 s48, 4, 0
    s_sub_u32 s50, s57, s56
    s_and_b32 s50, s50, 3
    s_add_u32 s48, s48, s50
    s_mov_b32 s46, 0x76543210
    s_mov_b32 s47, 0xdcba98
    s_cmp_eq_u32 s48, 1
    s_cselect_b32 s46, 0x76543210, s46
    s_cselect_b32 s47, 0xdcba98, s47
    s_cmp_eq_u32 s48, 2
    s_cselect_b32 s46, 0x76543210, s46
    s_cselect_b32 s47, 0xdcba98, s47
    s_cmp_eq_u32 s48, 3
    s_cselect_b32 s46, 0x76543210, s46
    s_cselect_b32 s47, 0xdcba98, s47
    s_cmp_eq_u32 s48, 4
    s_cselect_b32 s46, 0x76543210, s46
    s_cselect_b32 s47, 0xba98, s47
    s_cmp_eq_u32 s48, 5
    s_cselect_b32 s46, 0x76543210, s46
    s_cselect_b32 s47, 0xba98, s47
    s_cmp_eq_u32 s48, 6
    s_cselect_b32 s46, 0x76543210, s46
    s_cselect_b32 s47, 0xba98, s47
    s_cmp_eq_u32 s48, 7
    s_cselect_b32 s46, 0x76543210, s46
    s_cselect_b32 s47, 0xba98, s47
    v_mov_b32 v100, s75
    v_mov_b32 v101, 9
    s_mov_b64 exec, 1
    ds_write_b32 v100, v101
    s_mov_b64 exec, -1
    v_mov_b32 v100, 36
    s_mov_b32 s77, 0
L_lw29:
    ds_read_b32 v101, v100
    s_waitcnt lgkmcnt(0)
    v_cmp_ne_u32 vcc, 0, v101
    s_nop 0
    s_cmp_eq_u64 vcc, -1
    s_cbranch_scc1 L_lx29
    s_add_u32 s77, s77, 1
    s_cmp_ge_u32 s77, 160000
    s_cbranch_scc1 L_lx29
    s_sleep 1
    s_branch L_lw29
L_lx29:
    s_setprio 2
    s_branch L_g_nogelu
    s_nop 0
L_gwave:
    v_lshlrev_b32 v2, 4, v1
    v_add_u32 v3, 4096, v2
    s_mul_i32 s72, s57, 54
    s_mul_i32 s73, s3, 14
    s_add_u32 s72, s72, s73
    s_mul_i32 s72, s72, 5120
    s_add_u32 s72, s72, 12845056
    s_lshl_b32 s75, s3, 2
    s_add_u32 s75, s75, 16
    s_cmp_eq_u32 s3, 3
    s_cselect_b32 s49, 0x70000000, 0
    s_cselect_b32 s48, 4, 0
    s_sub_u32 s50, s57, s56
    s_and_b32 s50, s50, 3
    s_add_u32 s48, s48, s50
    s_mov_b32 s46, 0x76543210
    s_mov_b32 s47, 0xdcba98
    s_cmp_eq_u32 s48, 1
    s_cselect_b32 s46, 0x76543210, s46
    s_cselect_b32 s47, 0xdcba98, s47
    s_cmp_eq_u32 s48, 2
    s_cselect_b32 s46, 0x76543210, s46
    s_cselect_b32 s47, 0xdcba98, s47
    s_cmp_eq_u32 s48, 3
    s_cselect_b32 s46, 0x76543210, s46
    s_cselect_b32 s47, 0xdcba98, s47
    s_cmp_eq_u32 s48, 4
    s_cselect_b32 s46, 0x76543210, s46
    s_cselect_b32 s47, 0xba98, s47
    s_cmp_eq_u32 s48, 5
    s_cselect_b32 s46, 0x76543210, s46
    s_cselect_b32 s47, 0xba98, s47
    s_cmp_eq_u32 s48, 6
    s_cselect_b32 s46, 0x76543210, s46
    s_cselect_b32 s47, 0xba98, s47
    s_cmp_eq_u32 s48, 7
    s_cselect_b32 s46, 0x76543210, s46
    s_cselect_b32 s47, 0xba98, s47
    s_setprio 2
    s_and_b32 s62, s3, 1
    s_lshr_b32 s63, s3, 1
    s_lshl_b32 s64, s60, 1
    s_add_u32 s64, s64, s63
    s_lshl_b32 s71, s61, 1
    s_add_u32 s71, s71, s62
    s_lshl_b32 s70, s64, 5
    s_add_u32 s70, s70, s71
    s_lshl_b32 s70, s70, 7
    s_add_u32 s70, s70, 15159296
    s_mul_i32 s64, s64, 27
    s_add_u32 s64, s64, s71
    s_lshl_b32 s64, s64, 13
    s_add_u32 s66, s64, 5767168
    s_add_u32 s67, s66, 4096
    s_lshl_b32 s64, s63, 12
    s_add_u32 s66, s66, s64
    s_sub_u32 s67, s67, s64
    v_mov_b32 v141, 36
    s_cmp_eq_u32 s71, 27
    s_cbranch_scc1 L_g_idle
    v_lshrrev_b32 v144, 4, v1
    v_bfe_u32 v145, v1, 2, 2
    v_lshl_add_u32 v146, v144, 3, v145
    v_lshlrev_b32 v146, 8, v146
    v_and_b32 v147, 1, v144
    v_lshl_add_u32 v147, v147, 2, v145
    s_lshl_b32 s64, s62, 2
    s_lshl_b32 s65, s63, 1
    s_add_u32 s64, s64, s65
    v_xor_b32 v147, s64, v147
    v_lshl_add_u32 v146, v147, 5, v146
    v_and_b32 v147, 3, v1
    v_lshl_add_u32 v146, v147, 3, v146
    v_add_u32 v132, 16640, v146
    v_xor_b32 v133, 32, v132
    v_xor_b32 v134, 64, v132
    v_xor_b32 v135, 96, v132
    v_and_b32 v145, 15, v1
    v_lshrrev_b32 v146, 1, v145
    v_xor_b32 v146, v146, v144
    s_lshl_b32 s64, s63, 13
    s_add_u32 s64, s64, 256
    v_lshl_add_u32 v147, v145, 7, s64
    v_lshl_add_u32 v136, v146, 4, v147
    v_xor_b32 v137, 64, v136
    s_lshl_b32 s64, s63, 9
    s_add_u32 s64, s64, 65792
    v_lshl_add_u32 v138, v145, 3, s64
    s_lshl_b32 s64, s3, 9
    s_add_u32 s64, s64, 66816
    v_lshl_add_u32 v139, v1, 3, s64
    s_xor_b32 s64, s3, 2
    s_lshl_b32 s65, s64, 9
    s_add_u32 s65, s65, 66816
    v_lshl_add_u32 v140, v1, 3, s65
    s_lshl_b32 s64, s64, 2
    s_add_u32 s64, s64, 124
    v_and_b32 v146, 1, v1
    v_mul_u32_u24 v146, s64, v146
    v_add_u32 v141, v141, v146
    v_cmp_eq_u32 vcc, 0, v145
    v_mov_b32 v146, 0x3f803f80
    s_nop 0
    v_cndmask_b32 v156, 0, v146, vcc
    v_cndmask_b32 v157, 0, v146, vcc
    v_cndmask_b32 v158, 0, v146, vcc
    v_cndmask_b32 v159, 0, v146, vcc
    v_mov_b32 v168, 0
    v_mov_b32 v169, 0
    v_mov_b32 v170, 0
    v_mov_b32 v171, 0
    v_mov_b32 v172, 0
    v_mov_b32 v173, 0
    v_mov_b32 v174, 0
    v_mov_b32 v175, 0
    v_mov_b32 v4, 0
    v_mov_b32 v5, 0
    v_mov_b32 v6, 0
    v_mov_b32 v7, 0
    v_mov_b32 v8, 0
    v_mov_b32 v9, 0
    v_mov_b32 v10, 0
    v_mov_b32 v11, 0
    v_mov_b32 v12, 0
    v_mov_b32 v13, 0
    v_mov_b32 v14, 0
    v_mov_b32 v15, 0
    v_mov_b32 v16, 0
    v_mov_b32 v17, 0
    v_mov_b32 v18, 0
    v_mov_b32 v19, 0
    v_mov_b32 v20, 0
    v_mov_b32 v21, 0
    v_mov_b32 v22, 0
    v_mov_b32 v23, 0
    v_mov_b32 v24, 0
    v_mov_b32 v25, 0
    v_mov_b32 v26, 0
    v_mov_b32 v27, 0
    v_mov_b32 v28, 0
    v_mov_b32 v29, 0
    v_mov_b32 v30, 0
    v_mov_b32 v31, 0
    v_mov_b32 v32, 0
    v_mov_b32 v33, 0
    v_mov_b32 v34, 0
    v_mov_b32 v35, 0
    v_mov_b32 v36, 0
    v_mov_b32 v37, 0
    v_mov_b32 v38, 0
    v_mov_b32 v39, 0
    v_mov_b32 v40, 0
    v_mov_b32 v41, 0
    v_mov_b32 v42, 0
    v_mov_b32 v43, 0
    v_mov_b32 v44, 0
    v_mov_b32 v45, 0
    v_mov_b32 v46, 0
    v_mov_b32 v47, 0
    v_mov_b32 v48, 0
    v_mov_b32 v49, 0
    v_mov_b32 v50, 0
    v_mov_b32 v51, 0
    v_mov_b32 v52, 0
    v_mov_b32 v53, 0
    v_mov_b32 v54, 0
    v_mov_b32 v55, 0
    v_mov_b32 v56, 0
    v_mov_b32 v57, 0
    v_mov_b32 v58, 0
    v_mov_b32 v59, 0
    v_mov_b32 v60, 0
    v_mov_b32 v61, 0
    v_mov_b32 v62, 0
    v_mov_b32 v63, 0
    v_mov_b32 v64, 0
    v_mov_b32 v65, 0
    v_mov_b32 v66, 0
    v_mov_b32 v67, 0
    s_barrier
    ds_read_b64_tr_b16 v[68:69], v132 offset:0
    ds_read_b64_tr_b16 v[70:71], v132 offset:1024
    ds_read_b128 v[84:87], v136 offset:0
    ds_read_b128 v[88:91], v136 offset:2048
    ds_read_b128 v[92:95], v136 offset:4096
    ds_read_b128 v[96:99], v136 offset:6144
    ds_read_b64_tr_b16 v[72:73], v133 offset:0
    ds_read_b64_tr_b16 v[74:75], v133 offset:1024
    ds_read_b64_tr_b16 v[76:77], v134 offset:0
    ds_read_b64_tr_b16 v[78:79], v134 offset:1024
    ds_read_b64_tr_b16 v[80:81], v135 offset:0
    ds_read_b64_tr_b16 v[82:83], v135 offset:1024
    ds_read_b64_tr_b16 v[100:101], v132 offset:8192
    ds_read_b64_tr_b16 v[102:103], v132 offset:9216
    ds_read_b128 v[116:119], v137 offset:0
    ds_read_b128 v[120:123], v137 offset:2048
    ds_read_b128 v[124:127], v137 offset:4096
    ds_read_b128 v[128:131], v137 offset:6144
    ds_read_b64_tr_b16 v[104:105], v133 offset:8192
    ds_read_b64_tr_b16 v[106:107], v133 offset:9216
    ds_read_b64_tr_b16 v[108:109], v134 offset:8192
    ds_read_b64_tr_b16 v[110:111], v134 offset:9216
    ds_read_b64_tr_b16 v[112:113], v135 offset:8192
    ds_read_b64_tr_b16 v[114:115], v135 offset:9216
    s_mov_b32 s64, 1
    s_mov_b32 s65, 0
L_g1_loop:
    s_add_u32 s65, s65, 1
    s_cmp_eq_u32 s65, 3
    s_cselect_b32 s68, -2, 1
    s_cselect_b32 s65, 0, s65
    s_lshl_b32 s68, s68, 15
    s_waitcnt lgkmcnt(0)
    v_mfma_f32_16x16x32_bf16 v[4:7], v[68:71], v[84:87], v[4:7]
    v_add_u32 v132, s68, v132
    v_mfma_f32_16x16x32_bf16 v[4:7], v[100:103], v[116:119], v[4:7]
    v_add_u32 v133, s68, v133
    v_mfma_f32_16x16x32_bf16 v[12:15], v[100:103], v[120:123], v[12:15]
    v_add_u32 v134, s68, v134
    v_mfma_f32_16x16x32_bf16 v[12:15], v[68:71], v[88:91], v[12:15]
    v_add_u32 v135, s68, v135
    v_mfma_f32_16x16x32_bf16 v[20:23], v[68:71], v[92:95], v[20:23]
    v_add_u32 v136, s68, v136
    v_mfma_f32_16x16x32_bf16 v[20:23], v[100:103], v[124:127], v[20:23]
    v_add_u32 v137, s68, v137
    v_mfma_f32_16x16x32_bf16 v[28:31], v[100:103], v[128:131], v[28:31]
    v_mfma_f32_16x16x32_bf16 v[28:31], v[68:71], v[96:99], v[28:31]
    v_mfma_f32_16x16x32_bf16 v[32:35], v[72:75], v[96:99], v[32:35]
    v_mfma_f32_16x16x32_bf16 v[32:35], v[104:107], v[128:131], v[32:35]
    s_barrier
    s_add_u32 s64, s64, 1
    s_cmp_eq_u32 s64, 10
    v_mfma_f32_16x16x32_bf16 v[24:27], v[104:107], v[124:127], v[24:27]
    ds_read_b64_tr_b16 v[176:177], v132 offset:0
    ds_read_b64_tr_b16 v[178:179], v132 offset:1024
    v_mfma_f32_16x16x32_bf16 v[24:27], v[72:75], v[92:95], v[24:27]
    ds_read_b128 v[192:195], v136 offset:0
    v_mfma_f32_16x16x32_bf16 v[16:19], v[72:75], v[88:91], v[16:19]
    ds_read_b128 v[196:199], v136 offset:2048
    v_mfma_f32_16x16x32_bf16 v[16:19], v[104:107], v[120:123], v[16:19]
    ds_read_b128 v[200:203], v136 offset:4096
    v_mfma_f32_16x16x32_bf16 v[8:11], v[104:107], v[116:119], v[8:11]
    ds_read_b128 v[204:207], v136 offset:6144
    v_mfma_f32_16x16x32_bf16 v[8:11], v[72:75], v[84:87], v[8:11]
    ds_read_b64_tr_b16 v[180:181], v133 offset:0
    ds_read_b64_tr_b16 v[182:183], v133 offset:1024
    v_mfma_f32_16x16x32_bf16 v[36:39], v[76:79], v[84:87], v[36:39]
    ds_read_b64_tr_b16 v[184:185], v134 offset:0
    v_mfma_f32_16x16x32_bf16 v[36:39], v[108:111], v[116:119], v[36:39]
    ds_read_b64_tr_b16 v[186:187], v134 offset:1024
    v_mfma_f32_16x16x32_bf16 v[44:47], v[108:111], v[120:123], v[44:47]
    ds_read_b64_tr_b16 v[188:189], v135 offset:0
    v_mfma_f32_16x16x32_bf16 v[44:47], v[76:79], v[88:91], v[44:47]
    ds_read_b64_tr_b16 v[190:191], v135 offset:1024
    v_mfma_f32_16x16x32_bf16 v[52:55], v[76:79], v[92:95], v[52:55]
    ds_read_b64_tr_b16 v[208:209], v132 offset:8192
    ds_read_b64_tr_b16 v[210:211], v132 offset:9216
    v_mfma_f32_16x16x32_bf16 v[52:55], v[108:111], v[124:127], v[52:55]
    ds_read_b128 v[224:227], v137 offset:0
    v_mfma_f32_16x16x32_bf16 v[60:63], v[108:111], v[128:131], v[60:63]
    ds_read_b128 v[228:231], v137 offset:2048
    v_mfma_f32_16x16x32_bf16 v[60:63], v[76:79], v[96:99], v[60:63]
    ds_read_b128 v[232:235], v137 offset:4096
    v_mfma_f32_16x16x32_bf16 v[64:67], v[80:83], v[96:99], v[64:67]
    ds_read_b128 v[236:239], v137 offset:6144
    v_mfma_f32_16x16x32_bf16 v[64:67], v[112:115], v[128:131], v[64:67]
    ds_read_b64_tr_b16 v[212:213], v133 offset:8192
    ds_read_b64_tr_b16 v[214:215], v133 offset:9216
    v_mfma_f32_16x16x32_bf16 v[56:59], v[112:115], v[124:127], v[56:59]
    ds_read_b64_tr_b16 v[216:217], v134 offset:8192
    v_mfma_f32_16x16x32_bf16 v[56:59], v[80:83], v[92:95], v[56:59]
    ds_read_b64_tr_b16 v[218:219], v134 offset:9216
    v_mfma_f32_16x16x32_bf16 v[48:51], v[80:83], v[88:91], v[48:51]
    ds_read_b64_tr_b16 v[220:221], v135 offset:8192
    v_mfma_f32_16x16x32_bf16 v[48:51], v[112:115], v[120:123], v[48:51]
    ds_read_b64_tr_b16 v[222:223], v135 offset:9216
    v_mfma_f32_16x16x32_bf16 v[40:43], v[112:115], v[116:119], v[40:43]
    v_mfma_f32_16x16x32_bf16 v[40:43], v[80:83], v[84:87], v[40:43]
    v_mfma_f32_16x16x32_bf16 v[168:171], v[156:159], v[68:71], v[168:171]
    v_mfma_f32_16x16x32_bf16 v[168:171], v[156:159], v[100:103], v[168:171]
    v_mfma_f32_16x16x32_bf16 v[172:175], v[156:159], v[104:107], v[172:175]
    v_mfma_f32_16x16x32_bf16 v[172:175], v[156:159], v[72:75], v[172:175]
    s_cbranch_scc1 L_g1_last
    s_add_u32 s65, s65, 1
    s_cmp_eq_u32 s65, 3
    s_cselect_b32 s68, -2, 1
    s_cselect_b32 s65, 0, s65
    s_lshl_b32 s68, s68, 15
    s_waitcnt lgkmcnt(0)
    v_mfma_f32_16x16x32_bf16 v[4:7], v[176:179], v[192:195], v[4:7]
    v_add_u32 v132, s68, v132
    v_mfma_f32_16x16x32_bf16 v[4:7], v[208:211], v[224:227], v[4:7]
    v_add_u32 v133, s68, v133
    v_mfma_f32_16x16x32_bf16 v[12:15], v[208:211], v[228:231], v[12:15]
    v_add_u32 v134, s68, v134
    v_mfma_f32_16x16x32_bf16 v[12:15], v[176:179], v[196:199], v[12:15]
    v_add_u32 v135, s68, v135
    v_mfma_f32_16x16x32_bf16 v[20:23], v[176:179], v[200:203], v[20:23]
    v_add_u32 v136, s68, v136
    v_mfma_f32_16x16x32_bf16 v[20:23], v[208:211], v[232:235], v[20:23]
    v_add_u32 v137, s68, v137
    v_mfma_f32_16x16x32_bf16 v[28:31], v[208:211], v[236:239], v[28:31]
    v_mfma_f32_16x16x32_bf16 v[28:31], v[176:179], v[204:207], v[28:31]
    v_mfma_f32_16x16x32_bf16 v[32:35], v[180:183], v[204:207], v[32:35]
    v_mfma_f32_16x16x32_bf16 v[32:35], v[212:215], v[236:239], v[32:35]
    s_barrier
    s_add_u32 s64, s64, 1
    v_mfma_f32_16x16x32_bf16 v[24:27], v[212:215], v[232:235], v[24:27]
    ds_read_b64_tr_b16 v[68:69], v132 offset:0
    ds_read_b64_tr_b16 v[70:71], v132 offset:1024
    v_mfma_f32_16x16x32_bf16 v[24:27], v[180:183], v[200:203], v[24:27]
    ds_read_b128 v[84:87], v136 offset:0
    v_mfma_f32_16x16x32_bf16 v[16:19], v[180:183], v[196:199], v[16:19]
    ds_read_b128 v[88:91], v136 offset:2048
    v_mfma_f32_16x16x32_bf16 v[16:19], v[212:215], v[228:231], v[16:19]
    ds_read_b128 v[92:95], v136 offset:4096
    v_mfma_f32_16x16x32_bf16 v[8:11], v[212:215], v[224:227], v[8:11]
    ds_read_b128 v[96:99], v136 offset:6144
    v_mfma_f32_16x16x32_bf16 v[8:11], v[180:183], v[192:195], v[8:11]
    ds_read_b64_tr_b16 v[72:73], v133 offset:0
    ds_read_b64_tr_b16 v[74:75], v133 offset:1024
    v_mfma_f32_16x16x32_bf16 v[36:39], v[184:187], v[192:195], v[36:39]
    ds_read_b64_tr_b16 v[76:77], v134 offset:0
    v_mfma_f32_16x16x32_bf16 v[36:39], v[216:219], v[224:227], v[36:39]
    ds_read_b64_tr_b16 v[78:79], v134 offset:1024
    v_mfma_f32_16x16x32_bf16 v[44:47], v[216:219], v[228:231], v[44:47]
    ds_read_b64_tr_b16 v[80:81], v135 offset:0
    v_mfma_f32_16x16x32_bf16 v[44:47], v[184:187], v[196:199], v[44:47]
    ds_read_b64_tr_b16 v[82:83], v135 offset:1024
    v_mfma_f32_16x16x32_bf16 v[52:55], v[184:187], v[200:203], v[52:55]
    ds_read_b64_tr_b16 v[100:101], v132 offset:8192
    ds_read_b64_tr_b16 v[102:103], v132 offset:9216
    v_mfma_f32_16x16x32_bf16 v[52:55], v[216:219], v[232:235], v[52:55]
    ds_read_b128 v[116:119], v137 offset:0
    v_mfma_f32_16x16x32_bf16 v[60:63], v[216:219], v[236:239], v[60:63]
    ds_read_b128 v[120:123], v137 offset:2048
    v_mfma_f32_16x16x32_bf16 v[60:63], v[184:187], v[204:207], v[60:63]
    ds_read_b128 v[124:127], v137 offset:4096
    v_mfma_f32_16x16x32_bf16 v[64:67], v[188:191], v[204:207], v[64:67]
    ds_read_b128 v[128:131], v137 offset:6144
    v_mfma_f32_16x16x32_bf16 v[64:67], v[220:223], v[236:239], v[64:67]
    ds_read_b64_tr_b16 v[104:105], v133 offset:8192
    ds_read_b64_tr_b16 v[106:107], v133 offset:9216
    v_mfma_f32_16x16x32_bf16 v[56:59], v[220:223], v[232:235], v[56:59]
    ds_read_b64_tr_b16 v[108:109], v134 offset:8192
    v_mfma_f32_16x16x32_bf16 v[56:59], v[188:191], v[200:203], v[56:59]
    ds_read_b64_tr_b16 v[110:111], v134 offset:9216
    v_mfma_f32_16x16x32_bf16 v[48:51], v[188:191], v[196:199], v[48:51]
    ds_read_b64_tr_b16 v[112:113], v135 offset:8192
    v_mfma_f32_16x16x32_bf16 v[48:51], v[220:223], v[228:231], v[48:51]
    ds_read_b64_tr_b16 v[114:115], v135 offset:9216
    v_mfma_f32_16x16x32_bf16 v[40:43], v[220:223], v[224:227], v[40:43]
    v_mfma_f32_16x16x32_bf16 v[40:43], v[188:191], v[192:195], v[40:43]
    v_mfma_f32_16x16x32_bf16 v[168:171], v[156:159], v[176:179], v[168:171]
    v_mfma_f32_16x16x32_bf16 v[168:171], v[156:159], v[208:211], v[168:171]
    v_mfma_f32_16x16x32_bf16 v[172:175], v[156:159], v[212:215], v[172:175]
    v_mfma_f32_16x16x32_bf16 v[172:175], v[156:159], v[180:183], v[172:175]
    s_branch L_g1_loop
L_g1_last:
    s_waitcnt lgkmcnt(0)
    v_mfma_f32_16x16x32_bf16 v[168:171], v[156:159], v[176:179], v[168:171]
    v_mfma_f32_16x16x32_bf16 v[168:171], v[156:159], v[208:211], v[168:171]
    v_mfma_f32_16x16x32_bf16 v[172:175], v[156:159], v[212:215], v[172:175]
    v_mfma_f32_16x16x32_bf16 v[172:175], v[156:159], v[180:183], v[172:175]
    v_mfma_f32_16x16x32_bf16 v[4:7], v[176:179], v[192:195], v[4:7]
    v_mfma_f32_16x16x32_bf16 v[4:7], v[208:211], v[224:227], v[4:7]
    v_mfma_f32_16x16x32_bf16 v[12:15], v[208:211], v[228:231], v[12:15]
    v_mfma_f32_16x16x32_bf16 v[12:15], v[176:179], v[196:199], v[12:15]
    v_mfma_f32_16x16x32_bf16 v[20:23], v[176:179], v[200:203], v[20:23]
    v_mfma_f32_16x16x32_bf16 v[20:23], v[208:211], v[232:235], v[20:23]
    v_mfma_f32_16x16x32_bf16 v[28:31], v[208:211], v[236:239], v[28:31]
    v_mfma_f32_16x16x32_bf16 v[28:31], v[176:179], v[204:207], v[28:31]
    v_mfma_f32_16x16x32_bf16 v[32:35], v[180:183], v[204:207], v[32:35]
    v_mfma_f32_16x16x32_bf16 v[32:35], v[212:215], v[236:239], v[32:35]
    v_mfma_f32_16x16x32_bf16 v[24:27], v[212:215], v[232:235], v[24:27]
    v_mfma_f32_16x16x32_bf16 v[24:27], v[180:183], v[200:203], v[24:27]
    v_mfma_f32_16x16x32_bf16 v[16:19], v[180:183], v[196:199], v[16:19]
    v_mfma_f32_16x16x32_bf16 v[16:19], v[212:215], v[228:231], v[16:19]
    v_mfma_f32_16x16x32_bf16 v[8:11], v[212:215], v[224:227], v[8:11]
    v_mfma_f32_16x16x32_bf16 v[8:11], v[180:183], v[192:195], v[8:11]
    v_mfma_f32_16x16x32_bf16 v[36:39], v[184:187], v[192:195], v[36:39]
    v_cvt_pk_bf16_f32 v169, v168, v168
    v_cvt_pk_bf16_f32 v173, v172, v172
    v_mfma_f32_16x16x32_bf16 v[36:39], v[216:219], v[224:227], v[36:39]
    v_lshlrev_b32 v169, 16, v169
    v_lshlrev_b32 v173, 16, v173
    v_mfma_f32_16x16x32_bf16 v[44:47], v[216:219], v[228:231], v[44:47]
    v_sub_f32 v170, v168, v169
    v_mfma_f32_16x16x32_bf16 v[44:47], v[184:187], v[196:199], v[44:47]
    v_sub_f32 v174, v172, v173
    v_cvt_pk_bf16_f32 v160, v169, v170
    v_mfma_f32_16x16x32_bf16 v[52:55], v[184:187], v[200:203], v[52:55]
    v_cvt_pk_bf16_f32 v162, v173, v174
    v_mfma_f32_16x16x32_bf16 v[52:55], v[216:219], v[232:235], v[52:55]
    ds_write2_b32 v139, v160, v162 offset1:1
    s_add_u32 s64, s75, 144
    v_mov_b32 v142, s64
    v_mfma_f32_16x16x32_bf16 v[60:63], v[216:219], v[236:239], v[60:63]
    s_mov_b64 exec, 1
    ds_write_b32 v142, v142
    s_mov_b64 exec, -1
    v_mfma_f32_16x16x32_bf16 v[60:63], v[184:187], v[204:207], v[60:63]
    v_mfma_f32_16x16x32_bf16 v[64:67], v[188:191], v[204:207], v[64:67]
    v_mfma_f32_16x16x32_bf16 v[64:67], v[220:223], v[236:239], v[64:67]
    v_mfma_f32_16x16x32_bf16 v[56:59], v[220:223], v[232:235], v[56:59]
    v_mfma_f32_16x16x32_bf16 v[56:59], v[188:191], v[200:203], v[56:59]
    v_mfma_f32_16x16x32_bf16 v[48:51], v[188:191], v[196:199], v[48:51]
    v_mfma_f32_16x16x32_bf16 v[48:51], v[220:223], v[228:231], v[48:51]
    v_mfma_f32_16x16x32_bf16 v[40:43], v[220:223], v[224:227], v[40:43]
    v_mfma_f32_16x16x32_bf16 v[40:43], v[188:191], v[192:195], v[40:43]
    s_mov_b32 s77, 0
L_lw30:
    ds_read_b32 v143, v141
    s_waitcnt lgkmcnt(0)
    v_cmp_ne_u32 vcc, 0, v143
    s_nop 0
    s_cmp_eq_u64 vcc, -1
    s_cbranch_scc1 L_lx30
    s_add_u32 s77, s77, 1
    s_cmp_ge_u32 s77, 160000
    s_cbranch_scc1 L_lx30
    s_branch L_lw30
L_lx30:
    v_readfirstlane_b32 s59, v143
    ds_read_b64 v[68:69], v138 offset:0
    ds_read_b64 v[70:71], v138 offset:128
    ds_read_b64 v[72:73], v138 offset:256
    ds_read_b64 v[74:75], v138 offset:384
    ds_read_b32 v164, v140
    ds_read_b32 v166, v140 offset:4
    s_mul_i32 s63, s3, 14
    v_min_u32 v102, 13, v1
    v_add_u32 v102, s63, v102
    v_min_u32 v102, 53, v102
    v_lshlrev_b32 v102, 7, v102
    s_lshr_b32 s63, s57, 1
    s_lshl_b32 s63, s63, 13
    s_add_u32 s63, s63, 15126528
    s_waitcnt vmcnt(0) lgkmcnt(0)
    v_mov_b32 v100, s75
    v_mov_b32 v101, 11
    s_mov_b64 exec, 1
    ds_write_b32 v100, v101
    s_mov_b64 exec, -1
    v_mfma_f32_16x16x16_bf16 v[4:7], v[160:161], v[68:69], v[4:7]
    v_mfma_f32_16x16x16_bf16 v[12:15], v[160:161], v[70:71], v[12:15]
    v_mfma_f32_16x16x16_bf16 v[20:23], v[160:161], v[72:73], v[20:23]
    v_mfma_f32_16x16x16_bf16 v[28:31], v[160:161], v[74:75], v[28:31]
    v_mfma_f32_16x16x16_bf16 v[8:11], v[162:163], v[68:69], v[8:11]
    v_mfma_f32_16x16x16_bf16 v[16:19], v[162:163], v[70:71], v[16:19]
    v_mfma_f32_16x16x16_bf16 v[24:27], v[162:163], v[72:73], v[24:27]
    v_mfma_f32_16x16x16_bf16 v[32:35], v[162:163], v[74:75], v[32:35]
    v_mfma_f32_16x16x16_bf16 v[36:39], v[164:165], v[68:69], v[36:39]
    v_mfma_f32_16x16x16_bf16 v[44:47], v[164:165], v[70:71], v[44:47]
    v_mfma_f32_16x16x16_bf16 v[52:55], v[164:165], v[72:73], v[52:55]
    v_mfma_f32_16x16x16_bf16 v[60:63], v[164:165], v[74:75], v[60:63]
    v_mfma_f32_16x16x16_bf16 v[40:43], v[166:167], v[68:69], v[40:43]
    v_mfma_f32_16x16x16_bf16 v[48:51], v[166:167], v[70:71], v[48:51]
    v_mfma_f32_16x16x16_bf16 v[56:59], v[166:167], v[72:73], v[56:59]
    v_mfma_f32_16x16x16_bf16 v[64:67], v[166:167], v[74:75], v[64:67]
    s_mov_b32 s68, 0xc0135761
    s_mov_b32 s69, 0xbdd2d3e8
    v_lshlrev_b32 v112, 16, v69
    v_lshlrev_b32 v116, 16, v71
    v_lshlrev_b32 v120, 16, v73
    v_lshlrev_b32 v124, 16, v75
    v_rcp_f32 v113, v112
    v_rcp_f32 v117, v116
    v_rcp_f32 v121, v120
    v_rcp_f32 v125, v124
    v_mul_f32 v114, s68, v113
    v_mul_f32 v118, s68, v117
    v_mul_f32 v122, s68, v121
    v_mul_f32 v126, s68, v125
    v_mul_f32 v115, v113, v113
    v_mul_f32 v119, v117, v117
    v_mul_f32 v123, v121, v121
    v_mul_f32 v127, v125, v125
    v_mul_f32 v115, v115, v113
    v_mul_f32 v119, v119, v117
    v_mul_f32 v123, v123, v121
    v_mul_f32 v127, v127, v125
    v_mul_f32 v115, s69, v115
    v_mul_f32 v119, s69, v119
    v_mul_f32 v123, s69, v123
    v_mul_f32 v127, s69, v127
    v_pk_mul_f32 v[84:85], v[4:5], v[4:5]
    v_pk_mul_f32 v[86:87], v[6:7], v[6:7]
    v_pk_mul_f32 v[88:89], v[8:9], v[8:9]
    v_pk_mul_f32 v[90:91], v[10:11], v[10:11]
    v_pk_fma_f32 v[84:85], v[114:115], v[84:85], v[114:115] op_sel:[1,0,0] op_sel_hi:[1,1,0]
    v_pk_fma_f32 v[86:87], v[114:115], v[86:87], v[114:115] op_sel:[1,0,0] op_sel_hi:[1,1,0]
    v_pk_fma_f32 v[88:89], v[114:115], v[88:89], v[114:115] op_sel:[1,0,0] op_sel_hi:[1,1,0]
    v_pk_fma_f32 v[90:91], v[114:115], v[90:91], v[114:115] op_sel:[1,0,0] op_sel_hi:[1,1,0]
    v_pk_mul_f32 v[84:85], v[84:85], v[4:5]
    v_pk_mul_f32 v[86:87], v[86:87], v[6:7]
    v_pk_mul_f32 v[88:89], v[88:89], v[8:9]
    v_pk_mul_f32 v[90:91], v[90:91], v[10:11]
    v_exp_f32 v84, v84
    v_exp_f32 v85, v85
    v_exp_f32 v86, v86
    v_exp_f32 v87, v87
    v_exp_f32 v88, v88
    v_exp_f32 v89, v89
    v_exp_f32 v90, v90
    v_exp_f32 v91, v91
    v_pk_fma_f32 v[84:85], v[84:85], v[112:113], v[112:113] op_sel:[0,0,0] op_sel_hi:[1,0,0]
    v_pk_fma_f32 v[86:87], v[86:87], v[112:113], v[112:113] op_sel:[0,0,0] op_sel_hi:[1,0,0]
    v_pk_fma_f32 v[88:89], v[88:89], v[112:113], v[112:113] op_sel:[0,0,0] op_sel_hi:[1,0,0]
    v_pk_fma_f32 v[90:91], v[90:91], v[112:113], v[112:113] op_sel:[0,0,0] op_sel_hi:[1,0,0]
    v_rcp_f32 v84, v84
    v_rcp_f32 v85, v85
    v_rcp_f32 v86, v86
    v_rcp_f32 v87, v87
    v_rcp_f32 v88, v88
    v_rcp_f32 v89, v89
    v_rcp_f32 v90, v90
    v_rcp_f32 v91, v91
    v_pk_mul_f32 v[84:85], v[84:85], v[4:5]
    v_pk_mul_f32 v[86:87], v[86:87], v[6:7]
    v_pk_mul_f32 v[88:89], v[88:89], v[8:9]
    v_pk_mul_f32 v[90:91], v[90:91], v[10:11]
    v_cvt_pk_bf16_f32 v104, v84, v85
    v_cvt_pk_bf16_f32 v105, v86, v87
    v_cvt_pk_bf16_f32 v106, v88, v89
    v_cvt_pk_bf16_f32 v107, v90, v91
    buffer_store_dwordx4 v[104:107], v2, s[40:43], s66 offen offset:0 sc1
    v_pk_mul_f32 v[92:93], v[12:13], v[12:13]
    v_pk_mul_f32 v[94:95], v[14:15], v[14:15]
    v_pk_mul_f32 v[96:97], v[16:17], v[16:17]
    v_pk_mul_f32 v[98:99], v[18:19], v[18:19]
    v_pk_fma_f32 v[92:93], v[118:119], v[92:93], v[118:119] op_sel:[1,0,0] op_sel_hi:[1,1,0]
    v_pk_fma_f32 v[94:95], v[118:119], v[94:95], v[118:119] op_sel:[1,0,0] op_sel_hi:[1,1,0]
    v_pk_fma_f32 v[96:97], v[118:119], v[96:97], v[118:119] op_sel:[1,0,0] op_sel_hi:[1,1,0]
    v_pk_fma_f32 v[98:99], v[118:119], v[98:99], v[118:119] op_sel:[1,0,0] op_sel_hi:[1,1,0]
    v_pk_mul_f32 v[92:93], v[92:93], v[12:13]
    v_pk_mul_f32 v[94:95], v[94:95], v[14:15]
    v_pk_mul_f32 v[96:97], v[96:97], v[16:17]
    v_pk_mul_f32 v[98:99], v[98:99], v[18:19]
    v_exp_f32 v92, v92
    v_exp_f32 v93, v93
    v_exp_f32 v94, v94
    v_exp_f32 v95, v95
    v_exp_f32 v96, v96
    v_exp_f32 v97, v97
    v_exp_f32 v98, v98
    v_exp_f32 v99, v99
    v_pk_fma_f32 v[92:93], v[92:93], v[116:117], v[116:117] op_sel:[0,0,0] op_sel_hi:[1,0,0]
    v_pk_fma_f32 v[94:95], v[94:95], v[116:117], v[116:117] op_sel:[0,0,0] op_sel_hi:[1,0,0]
    v_pk_fma_f32 v[96:97], v[96:97], v[116:117], v[116:117] op_sel:[0,0,0] op_sel_hi:[1,0,0]
    v_pk_fma_f32 v[98:99], v[98:99], v[116:117], v[116:117] op_sel:[0,0,0] op_sel_hi:[1,0,0]
    v_rcp_f32 v92, v92
    v_rcp_f32 v93, v93
    v_rcp_f32 v94, v94
    v_rcp_f32 v95, v95
    v_rcp_f32 v96, v96
    v_rcp_f32 v97, v97
    v_rcp_f32 v98, v98
    v_rcp_f32 v99, v99
    v_pk_mul_f32 v[92:93], v[92:93], v[12:13]
    v_pk_mul_f32 v[94:95], v[94:95], v[14:15]
    v_pk_mul_f32 v[96:97], v[96:97], v[16:17]
    v_pk_mul_f32 v[98:99], v[98:99], v[18:19]
    v_cvt_pk_bf16_f32 v108, v92, v93
    v_cvt_pk_bf16_f32 v109, v94, v95
    v_cvt_pk_bf16_f32 v110, v96, v97
    v_cvt_pk_bf16_f32 v111, v98, v99
    buffer_store_dwordx4 v[108:111], v2, s[40:43], s66 offen offset:1024 sc1
    v_pk_mul_f32 v[84:85], v[20:21], v[20:21]
    v_pk_mul_f32 v[86:87], v[22:23], v[22:23]
    v_pk_mul_f32 v[88:89], v[24:25], v[24:25]
    v_pk_mul_f32 v[90:91], v[26:27], v[26:27]
    v_pk_fma_f32 v[84:85], v[122:123], v[84:85], v[122:123] op_sel:[1,0,0] op_sel_hi:[1,1,0]
    v_pk_fma_f32 v[86:87], v[122:123], v[86:87], v[122:123] op_sel:[1,0,0] op_sel_hi:[1,1,0]
    v_pk_fma_f32 v[88:89], v[122:123], v[88:89], v[122:123] op_sel:[1,0,0] op_sel_hi:[1,1,0]
    v_pk_fma_f32 v[90:91], v[122:123], v[90:91], v[122:123] op_sel:[1,0,0] op_sel_hi:[1,1,0]
    v_pk_mul_f32 v[84:85], v[84:85], v[20:21]
    v_pk_mul_f32 v[86:87], v[86:87], v[22:23]
    v_pk_mul_f32 v[88:89], v[88:89], v[24:25]
    v_pk_mul_f32 v[90:91], v[90:91], v[26:27]
    v_exp_f32 v84, v84
    v_exp_f32 v85, v85
    v_exp_f32 v86, v86
    v_exp_f32 v87, v87
    v_exp_f32 v88, v88
    v_exp_f32 v89, v89
    v_exp_f32 v90, v90
    v_exp_f32 v91, v91
    v_pk_fma_f32 v[84:85], v[84:85], v[120:121], v[120:121] op_sel:[0,0,0] op_sel_hi:[1,0,0]
    v_pk_fma_f32 v[86:87], v[86:87], v[120:121], v[120:121] op_sel:[0,0,0] op_sel_hi:[1,0,0]
    v_pk_fma_f32 v[88:89], v[88:89], v[120:121], v[120:121] op_sel:[0,0,0] op_sel_hi:[1,0,0]
    v_pk_fma_f32 v[90:91], v[90:91], v[120:121], v[120:121] op_sel:[0,0,0] op_sel_hi:[1,0,0]
    v_rcp_f32 v84, v84
    v_rcp_f32 v85, v85
    v_rcp_f32 v86, v86
    v_rcp_f32 v87, v87
    v_rcp_f32 v88, v88
    v_rcp_f32 v89, v89
    v_rcp_f32 v90, v90
    v_rcp_f32 v91, v91
    v_pk_mul_f32 v[84:85], v[84:85], v[20:21]
    v_pk_mul_f32 v[86:87], v[86:87], v[22:23]
    v_pk_mul_f32 v[88:89], v[88:89], v[24:25]
    v_pk_mul_f32 v[90:91], v[90:91], v[26:27]
    v_cvt_pk_bf16_f32 v104, v84, v85
    v_cvt_pk_bf16_f32 v105, v86, v87
    v_cvt_pk_bf16_f32 v106, v88, v89
    v_cvt_pk_bf16_f32 v107, v90, v91
    buffer_store_dwordx4 v[104:107], v2, s[40:43], s66 offen offset:2048 sc1
    v_pk_mul_f32 v[92:93], v[28:29], v[28:29]
    v_pk_mul_f32 v[94:95], v[30:31], v[30:31]
    v_pk_mul_f32 v[96:97], v[32:33], v[32:33]
    v_pk_mul_f32 v[98:99], v[34:35], v[34:35]
    v_pk_fma_f32 v[92:93], v[126:127], v[92:93], v[126:127] op_sel:[1,0,0] op_sel_hi:[1,1,0]
    v_pk_fma_f32 v[94:95], v[126:127], v[94:95], v[126:127] op_sel:[1,0,0] op_sel_hi:[1,1,0]
    v_pk_fma_f32 v[96:97], v[126:127], v[96:97], v[126:127] op_sel:[1,0,0] op_sel_hi:[1,1,0]
    v_pk_fma_f32 v[98:99], v[126:127], v[98:99], v[126:127] op_sel:[1,0,0] op_sel_hi:[1,1,0]
    v_pk_mul_f32 v[92:93], v[92:93], v[28:29]
    v_pk_mul_f32 v[94:95], v[94:95], v[30:31]
    v_pk_mul_f32 v[96:97], v[96:97], v[32:33]
    v_pk_mul_f32 v[98:99], v[98:99], v[34:35]
    v_exp_f32 v92, v92
    v_exp_f32 v93, v93
    v_exp_f32 v94, v94
    v_exp_f32 v95, v95
    v_exp_f32 v96, v96
    v_exp_f32 v97, v97
    v_exp_f32 v98, v98
    v_exp_f32 v99, v99
    v_pk_fma_f32 v[92:93], v[92:93], v[124:125], v[124:125] op_sel:[0,0,0] op_sel_hi:[1,0,0]
    v_pk_fma_f32 v[94:95], v[94:95], v[124:125], v[124:125] op_sel:[0,0,0] op_sel_hi:[1,0,0]
    v_pk_fma_f32 v[96:97], v[96:97], v[124:125], v[124:125] op_sel:[0,0,0] op_sel_hi:[1,0,0]
    v_pk_fma_f32 v[98:99], v[98:99], v[124:125], v[124:125] op_sel:[0,0,0] op_sel_hi:[1,0,0]
    v_rcp_f32 v92, v92
    v_rcp_f32 v93, v93
    v_rcp_f32 v94, v94
    v_rcp_f32 v95, v95
    v_rcp_f32 v96, v96
    v_rcp_f32 v97, v97
    v_rcp_f32 v98, v98
    v_rcp_f32 v99, v99
    v_pk_mul_f32 v[92:93], v[92:93], v[28:29]
    v_pk_mul_f32 v[94:95], v[94:95], v[30:31]
    v_pk_mul_f32 v[96:97], v[96:97], v[32:33]
    v_pk_mul_f32 v[98:99], v[98:99], v[34:35]
    v_cvt_pk_bf16_f32 v108, v92, v93
    v_cvt_pk_bf16_f32 v109, v94, v95
    v_cvt_pk_bf16_f32 v110, v96, v97
    v_cvt_pk_bf16_f32 v111, v98, v99
    buffer_store_dwordx4 v[108:111], v2, s[40:43], s66 offen offset:3072 sc1
    v_pk_mul_f32 v[84:85], v[36:37], v[36:37]
    v_pk_mul_f32 v[86:87], v[38:39], v[38:39]
    v_pk_mul_f32 v[88:89], v[40:41], v[40:41]
    v_pk_mul_f32 v[90:91], v[42:43], v[42:43]
    v_pk_fma_f32 v[84:85], v[114:115], v[84:85], v[114:115] op_sel:[1,0,0] op_sel_hi:[1,1,0]
    v_pk_fma_f32 v[86:87], v[114:115], v[86:87], v[114:115] op_sel:[1,0,0] op_sel_hi:[1,1,0]
    v_pk_fma_f32 v[88:89], v[114:115], v[88:89], v[114:115] op_sel:[1,0,0] op_sel_hi:[1,1,0]
    v_pk_fma_f32 v[90:91], v[114:115], v[90:91], v[114:115] op_sel:[1,0,0] op_sel_hi:[1,1,0]
    v_pk_mul_f32 v[84:85], v[84:85], v[36:37]
    v_pk_mul_f32 v[86:87], v[86:87], v[38:39]
    v_pk_mul_f32 v[88:89], v[88:89], v[40:41]
    v_pk_mul_f32 v[90:91], v[90:91], v[42:43]
    v_exp_f32 v84, v84
    v_exp_f32 v85, v85
    v_exp_f32 v86, v86
    v_exp_f32 v87, v87
    v_exp_f32 v88, v88
    v_exp_f32 v89, v89
    v_exp_f32 v90, v90
    v_exp_f32 v91, v91
    v_pk_fma_f32 v[84:85], v[84:85], v[112:113], v[112:113] op_sel:[0,0,0] op_sel_hi:[1,0,0]
    v_pk_fma_f32 v[86:87], v[86:87], v[112:113], v[112:113] op_sel:[0,0,0] op_sel_hi:[1,0,0]
    v_pk_fma_f32 v[88:89], v[88:89], v[112:113], v[112:113] op_sel:[0,0,0] op_sel_hi:[1,0,0]
    v_pk_fma_f32 v[90:91], v[90:91], v[112:113], v[112:113] op_sel:[0,0,0] op_sel_hi:[1,0,0]
    v_rcp_f32 v84, v84
    v_rcp_f32 v85, v85
    v_rcp_f32 v86, v86
    v_rcp_f32 v87, v87
    v_rcp_f32 v88, v88
    v_rcp_f32 v89, v89
    v_rcp_f32 v90, v90
    v_rcp_f32 v91, v91
    v_pk_mul_f32 v[84:85], v[84:85], v[36:37]
    v_pk_mul_f32 v[86:87], v[86:87], v[38:39]
    v_pk_mul_f32 v[88:89], v[88:89], v[40:41]
    v_pk_mul_f32 v[90:91], v[90:91], v[42:43]
    v_cvt_pk_bf16_f32 v104, v84, v85
    v_cvt_pk_bf16_f32 v105, v86, v87
    v_cvt_pk_bf16_f32 v106, v88, v89
    v_cvt_pk_bf16_f32 v107, v90, v91
    buffer_store_dwordx4 v[104:107], v2, s[40:43], s67 offen offset:0 sc1
    v_pk_mul_f32 v[92:93], v[44:45], v[44:45]
    v_pk_mul_f32 v[94:95], v[46:47], v[46:47]
    v_pk_mul_f32 v[96:97], v[48:49], v[48:49]
    v_pk_mul_f32 v[98:99], v[50:51], v[50:51]
    v_pk_fma_f32 v[92:93], v[118:119], v[92:93], v[118:119] op_sel:[1,0,0] op_sel_hi:[1,1,0]
    v_pk_fma_f32 v[94:95], v[118:119], v[94:95], v[118:119] op_sel:[1,0,0] op_sel_hi:[1,1,0]
    v_pk_fma_f32 v[96:97], v[118:119], v[96:97], v[118:119] op_sel:[1,0,0] op_sel_hi:[1,1,0]
    v_pk_fma_f32 v[98:99], v[118:119], v[98:99], v[118:119] op_sel:[1,0,0] op_sel_hi:[1,1,0]
    v_pk_mul_f32 v[92:93], v[92:93], v[44:45]
    v_pk_mul_f32 v[94:95], v[94:95], v[46:47]
    v_pk_mul_f32 v[96:97], v[96:97], v[48:49]
    v_pk_mul_f32 v[98:99], v[98:99], v[50:51]
    v_exp_f32 v92, v92
    v_exp_f32 v93, v93
    v_exp_f32 v94, v94
    v_exp_f32 v95, v95
    v_exp_f32 v96, v96
    v_exp_f32 v97, v97
    v_exp_f32 v98, v98
    v_exp_f32 v99, v99
    v_pk_fma_f32 v[92:93], v[92:93], v[116:117], v[116:117] op_sel:[0,0,0] op_sel_hi:[1,0,0]
    v_pk_fma_f32 v[94:95], v[94:95], v[116:117], v[116:117] op_sel:[0,0,0] op_sel_hi:[1,0,0]
    v_pk_fma_f32 v[96:97], v[96:97], v[116:117], v[116:117] op_sel:[0,0,0] op_sel_hi:[1,0,0]
    v_pk_fma_f32 v[98:99], v[98:99], v[116:117], v[116:117] op_sel:[0,0,0] op_sel_hi:[1,0,0]
    v_rcp_f32 v92, v92
    v_rcp_f32 v93, v93
    v_rcp_f32 v94, v94
    v_rcp_f32 v95, v95
    v_rcp_f32 v96, v96
    v_rcp_f32 v97, v97
    v_rcp_f32 v98, v98
    v_rcp_f32 v99, v99
    v_pk_mul_f32 v[92:93], v[92:93], v[44:45]
    v_pk_mul_f32 v[94:95], v[94:95], v[46:47]
    v_pk_mul_f32 v[96:97], v[96:97], v[48:49]
    v_pk_mul_f32 v[98:99], v[98:99], v[50:51]
    v_cvt_pk_bf16_f32 v108, v92, v93
    v_cvt_pk_bf16_f32 v109, v94, v95
    v_cvt_pk_bf16_f32 v110, v96, v97
    v_cvt_pk_bf16_f32 v111, v98, v99
    buffer_store_dwordx4 v[108:111], v2, s[40:43], s67 offen offset:1024 sc1
    v_pk_mul_f32 v[84:85], v[52:53], v[52:53]
    v_pk_mul_f32 v[86:87], v[54:55], v[54:55]
    v_pk_mul_f32 v[88:89], v[56:57], v[56:57]
    v_pk_mul_f32 v[90:91], v[58:59], v[58:59]
    v_pk_fma_f32 v[84:85], v[122:123], v[84:85], v[122:123] op_sel:[1,0,0] op_sel_hi:[1,1,0]
    v_pk_fma_f32 v[86:87], v[122:123], v[86:87], v[122:123] op_sel:[1,0,0] op_sel_hi:[1,1,0]
    v_pk_fma_f32 v[88:89], v[122:123], v[88:89], v[122:123] op_sel:[1,0,0] op_sel_hi:[1,1,0]
    v_pk_fma_f32 v[90:91], v[122:123], v[90:91], v[122:123] op_sel:[1,0,0] op_sel_hi:[1,1,0]
    v_pk_mul_f32 v[84:85], v[84:85], v[52:53]
    v_pk_mul_f32 v[86:87], v[86:87], v[54:55]
    v_pk_mul_f32 v[88:89], v[88:89], v[56:57]
    v_pk_mul_f32 v[90:91], v[90:91], v[58:59]
    v_exp_f32 v84, v84
    v_exp_f32 v85, v85
    v_exp_f32 v86, v86
    v_exp_f32 v87, v87
    v_exp_f32 v88, v88
    v_exp_f32 v89, v89
    v_exp_f32 v90, v90
    v_exp_f32 v91, v91
    v_pk_fma_f32 v[84:85], v[84:85], v[120:121], v[120:121] op_sel:[0,0,0] op_sel_hi:[1,0,0]
    v_pk_fma_f32 v[86:87], v[86:87], v[120:121], v[120:121] op_sel:[0,0,0] op_sel_hi:[1,0,0]
    v_pk_fma_f32 v[88:89], v[88:89], v[120:121], v[120:121] op_sel:[0,0,0] op_sel_hi:[1,0,0]
    v_pk_fma_f32 v[90:91], v[90:91], v[120:121], v[120:121] op_sel:[0,0,0] op_sel_hi:[1,0,0]
    v_rcp_f32 v84, v84
    v_rcp_f32 v85, v85
    v_rcp_f32 v86, v86
    v_rcp_f32 v87, v87
    v_rcp_f32 v88, v88
    v_rcp_f32 v89, v89
    v_rcp_f32 v90, v90
    v_rcp_f32 v91, v91
    v_pk_mul_f32 v[84:85], v[84:85], v[52:53]
    v_pk_mul_f32 v[86:87], v[86:87], v[54:55]
    v_pk_mul_f32 v[88:89], v[88:89], v[56:57]
    v_pk_mul_f32 v[90:91], v[90:91], v[58:59]
    v_cvt_pk_bf16_f32 v104, v84, v85
    v_cvt_pk_bf16_f32 v105, v86, v87
    v_cvt_pk_bf16_f32 v106, v88, v89
    v_cvt_pk_bf16_f32 v107, v90, v91
    buffer_store_dwordx4 v[104:107], v2, s[40:43], s67 offen offset:2048 sc1
    buffer_load_dword v103, v102, s[40:43], s63 offen sc1
    v_pk_mul_f32 v[92:93], v[60:61], v[60:61]
    v_pk_mul_f32 v[94:95], v[62:63], v[62:63]
    v_pk_mul_f32 v[96:97], v[64:65], v[64:65]
    v_pk_mul_f32 v[98:99], v[66:67], v[66:67]
    v_pk_fma_f32 v[92:93], v[126:127], v[92:93], v[126:127] op_sel:[1,0,0] op_sel_hi:[1,1,0]
    v_pk_fma_f32 v[94:95], v[126:127], v[94:95], v[126:127] op_sel:[1,0,0] op_sel_hi:[1,1,0]
    v_pk_fma_f32 v[96:97], v[126:127], v[96:97], v[126:127] op_sel:[1,0,0] op_sel_hi:[1,1,0]
    v_pk_fma_f32 v[98:99], v[126:127], v[98:99], v[126:127] op_sel:[1,0,0] op_sel_hi:[1,1,0]
    v_pk_mul_f32 v[92:93], v[92:93], v[60:61]
    v_pk_mul_f32 v[94:95], v[94:95], v[62:63]
    v_pk_mul_f32 v[96:97], v[96:97], v[64:65]
    v_pk_mul_f32 v[98:99], v[98:99], v[66:67]
    v_exp_f32 v92, v92
    v_exp_f32 v93, v93
    v_exp_f32 v94, v94
    v_exp_f32 v95, v95
    v_exp_f32 v96, v96
    v_exp_f32 v97, v97
    v_exp_f32 v98, v98
    v_exp_f32 v99, v99
    v_pk_fma_f32 v[92:93], v[92:93], v[124:125], v[124:125] op_sel:[0,0,0] op_sel_hi:[1,0,0]
    v_pk_fma_f32 v[94:95], v[94:95], v[124:125], v[124:125] op_sel:[0,0,0] op_sel_hi:[1,0,0]
    v_pk_fma_f32 v[96:97], v[96:97], v[124:125], v[124:125] op_sel:[0,0,0] op_sel_hi:[1,0,0]
    v_pk_fma_f32 v[98:99], v[98:99], v[124:125], v[124:125] op_sel:[0,0,0] op_sel_hi:[1,0,0]
    v_rcp_f32 v92, v92
    v_rcp_f32 v93, v93
    v_rcp_f32 v94, v94
    v_rcp_f32 v95, v95
    v_rcp_f32 v96, v96
    v_rcp_f32 v97, v97
    v_rcp_f32 v98, v98
    v_rcp_f32 v99, v99
    v_pk_mul_f32 v[92:93], v[92:93], v[60:61]
    v_pk_mul_f32 v[94:95], v[94:95], v[62:63]
    v_pk_mul_f32 v[96:97], v[96:97], v[64:65]
    v_pk_mul_f32 v[98:99], v[98:99], v[66:67]
    v_cvt_pk_bf16_f32 v108, v92, v93
    v_cvt_pk_bf16_f32 v109, v94, v95
    v_cvt_pk_bf16_f32 v110, v96, v97
    v_cvt_pk_bf16_f32 v111, v98, v99
    buffer_store_dwordx4 v[108:111], v2, s[40:43], s67 offen offset:3072 sc1
    v_mov_b32 v100, s75
    v_mov_b32 v101, 12
    s_mov_b64 exec, 1
    ds_write_b32 v100, v101
    s_mov_b64 exec, -1
    s_waitcnt vmcnt(1)
    v_cmp_eq_u32 vcc, s59, v103
    s_nop 0
    s_cmp_eq_u64 vcc, -1
    s_cbranch_scc0 L_g_wlate
    s_bfe_u32 s74, s46, 0x40000
    s_mul_i32 s74, s74, 5120
    s_add_u32 s74, s74, s72
    buffer_load_dwordx4 v[116:119], v2, s[40:43], s74 offen offset:0 sc1
    buffer_load_dwordx4 v[120:123], v2, s[40:43], s74 offen offset:1024 sc1
    buffer_load_dwordx4 v[124:127], v2, s[40:43], s74 offen offset:2048 sc1
    buffer_load_dwordx4 v[128:131], v2, s[40:43], s74 offen offset:3072 sc1
    buffer_load_dwordx4 v[132:135], v3, s[40:43], s74 offen sc1
    s_bfe_u32 s74, s46, 0x40004
    s_mul_i32 s74, s74, 5120
    s_add_u32 s74, s74, s72
    buffer_load_dwordx4 v[136:139], v2, s[40:43], s74 offen offset:0 sc1
    buffer_load_dwordx4 v[140:143], v2, s[40:43], s74 offen offset:1024 sc1
    buffer_load_dwordx4 v[144:147], v2, s[40:43], s74 offen offset:2048 sc1
    buffer_load_dwordx4 v[148:151], v2, s[40:43], s74 offen offset:3072 sc1
    buffer_load_dwordx4 v[152:155], v3, s[40:43], s74 offen sc1
    s_waitcnt vmcnt(10)
    v_lshlrev_b32 v100, 2, v1
    v_mov_b32 v101, s59
    s_mov_b32 exec_hi, 0
    buffer_store_dword v101, v100, s[40:43], s70 offen sc1
    s_mov_b64 exec, -1
    s_branch L_g_wok
L_g_wlate:
    buffer_load_dword v103, v102, s[40:43], s63 offen sc1
    s_waitcnt vmcnt(1)
    v_lshlrev_b32 v100, 2, v1
    v_mov_b32 v101, s59
    s_mov_b32 exec_hi, 0
    buffer_store_dword v101, v100, s[40:43], s70 offen sc1
    s_mov_b64 exec, -1
    s_waitcnt vmcnt(1)
    v_cmp_eq_u32 vcc, s59, v103
    s_nop 0
    s_cmp_eq_u64 vcc, -1
    s_cbranch_scc1 L_g_wok2
    s_branch L_g_post
L_g_idle:
    s_barrier
    s_barrier
    s_barrier
    s_barrier
    s_barrier
    s_barrier
    s_barrier
    s_barrier
    s_barrier
    s_barrier
    s_mov_b32 s77, 0
L_lw31:
    ds_read_b32 v143, v141
    s_waitcnt lgkmcnt(0)
    v_cmp_ne_u32 vcc, 0, v143
    s_nop 0
    s_cmp_eq_u64 vcc, -1
    s_cbranch_scc1 L_lx31
    s_add_u32 s77, s77, 1
    s_cmp_ge_u32 s77, 160000
    s_cbranch_scc1 L_lx31
    s_sleep 2
    s_branch L_lw31
L_lx31:
    v_readfirstlane_b32 s59, v143
L_g_nogelu:
    v_mov_b32 v100, s75
    v_mov_b32 v101, 12
    s_mov_b64 exec, 1
    ds_write_b32 v100, v101
    s_mov_b64 exec, -1
    s_mul_i32 s63, s3, 14
    v_min_u32 v102, 13, v1
    v_add_u32 v102, s63, v102
    v_min_u32 v102, 53, v102
    v_lshlrev_b32 v102, 7, v102
    s_lshr_b32 s63, s57, 1
    s_lshl_b32 s63, s63, 13
    s_add_u32 s63, s63, 15126528
    v_and_b32 v100, 3, v1
    v_lshlrev_b32 v100, 2, v100
    v_add_u32 v100, 48, v100
    s_mov_b32 s77, 0
L_lw32:
    ds_read_b32 v101, v100
    s_waitcnt lgkmcnt(0)
    v_cmp_ne_u32 vcc, 0, v101
    s_nop 0
    s_cmp_eq_u64 vcc, -1
    s_cbranch_scc1 L_lx32
    s_add_u32 s77, s77, 1
    s_cmp_ge_u32 s77, 160000
    s_cbranch_scc1 L_lx32
    s_sleep 2
    s_branch L_lw32
L_lx32:
L_g_post:
    s_mov_b32 s77, 0
L_gp33:
    buffer_load_dword v103, v102, s[40:43], s63 offen sc1
    s_waitcnt vmcnt(0)
    v_cmp_eq_u32 vcc, s59, v103
    s_nop 0
    s_cmp_eq_u64 vcc, -1
    s_cbranch_scc1 L_gx33
    s_add_u32 s77, s77, 1
    s_cmp_ge_u32 s77, 20000
    s_cbranch_scc1 L_gx33
    s_sleep 2
    s_branch L_gp33
L_gx33:
L_g_wok2:
    s_bfe_u32 s74, s46, 0x40000
    s_mul_i32 s74, s74, 5120
    s_add_u32 s74, s74, s72
    buffer_load_dwordx4 v[116:119], v2, s[40:43], s74 offen offset:0 sc1
    buffer_load_dwordx4 v[120:123], v2, s[40:43], s74 offen offset:1024 sc1
    buffer_load_dwordx4 v[124:127], v2, s[40:43], s74 offen offset:2048 sc1
    buffer_load_dwordx4 v[128:131], v2, s[40:43], s74 offen offset:3072 sc1
    buffer_load_dwordx4 v[132:135], v3, s[40:43], s74 offen sc1
    s_bfe_u32 s74, s46, 0x40004
    s_mul_i32 s74, s74, 5120
    s_add_u32 s74, s74, s72
    buffer_load_dwordx4 v[136:139], v2, s[40:43], s74 offen offset:0 sc1
    buffer_load_dwordx4 v[140:143], v2, s[40:43], s74 offen offset:1024 sc1
    buffer_load_dwordx4 v[144:147], v2, s[40:43], s74 offen offset:2048 sc1
    buffer_load_dwordx4 v[148:151], v2, s[40:43], s74 offen offset:3072 sc1
    buffer_load_dwordx4 v[152:155], v3, s[40:43], s74 offen sc1
L_g_wok:
    s_mov_b32 s51, 0
L_g_stage:
    s_mul_i32 s63, s3, 7
    v_min_u32 v104, 6, v1
    v_add_u32 v104, s63, v104
    v_min_u32 v104, 26, v104
    v_lshlrev_b32 v104, 7, v104
    s_lshl_b32 s63, s56, 12
    s_add_u32 s63, s63, 15159296
    s_mul_i32 s66, s56, 54
    s_mul_i32 s67, s3, 14
    s_add_u32 s66, s66, s67
    s_lshl_b32 s66, s66, 12
    s_add_u32 s66, s66, 5767168
    v_mov_b32 v100, 124
    s_mov_b32 s77, 0
L_lw34:
    ds_read_b32 v101, v100
    s_waitcnt lgkmcnt(0)
    v_cmp_ne_u32 vcc, 0, v101
    s_nop 0
    s_cmp_eq_u64 vcc, -1
    s_cbranch_scc1 L_lx34
    s_add_u32 s77, s77, 1
    s_cmp_ge_u32 s77, 160000
    s_cbranch_scc1 L_lx34
    s_sleep 1
    s_branch L_lw34
L_lx34:
    s_mul_i32 s64, s3, 20480
    s_add_u32 s64, s64, 256
    s_bfe_u32 s74, s47, 0x40008
    s_mul_i32 s74, s74, 5120
    s_add_u32 s74, s74, s72
    s_add_u32 m0, s64, 0
    s_nop 0
    buffer_load_dwordx4 v2, s[40:43], s74 offen offset:0 sc1 lds
    buffer_load_dwordx4 v2, s[40:43], s74 offen offset:1024 sc1 lds
    buffer_load_dwordx4 v2, s[40:43], s74 offen offset:2048 sc1 lds
    buffer_load_dwordx4 v2, s[40:43], s74 offen offset:3072 sc1 lds
    s_add_u32 m0, s64, 4096
    s_nop 0
    buffer_load_dwordx4 v3, s[40:43], s74 offen sc1 lds
    s_bfe_u32 s74, s47, 0x4000c
    s_mul_i32 s74, s74, 5120
    s_add_u32 s74, s74, s72
    s_add_u32 m0, s64, 5120
    s_nop 0
    buffer_load_dwordx4 v2, s[40:43], s74 offen offset:0 sc1 lds
    buffer_load_dwordx4 v2, s[40:43], s74 offen offset:1024 sc1 lds
    buffer_load_dwordx4 v2, s[40:43], s74 offen offset:2048 sc1 lds
    buffer_load_dwordx4 v2, s[40:43], s74 offen offset:3072 sc1 lds
    s_add_u32 m0, s64, 9216
    s_nop 0
    buffer_load_dwordx4 v3, s[40:43], s74 offen sc1 lds
    s_bfe_u32 s74, s47, 0x40010
    s_mul_i32 s74, s74, 5120
    s_add_u32 s74, s74, s72
    s_add_u32 s74, s74, s49
    s_add_u32 m0, s64, 10240
    s_nop 0
    buffer_load_dwordx4 v2, s[40:43], s74 offen offset:0 sc1 lds
    buffer_load_dwordx4 v2, s[40:43], s74 offen offset:1024 sc1 lds
    buffer_load_dwordx4 v2, s[40:43], s74 offen offset:2048 sc1 lds
    buffer_load_dwordx4 v2, s[40:43], s74 offen offset:3072 sc1 lds
    s_add_u32 m0, s64, 14336
    s_nop 0
    buffer_load_dwordx4 v3, s[40:43], s74 offen sc1 lds
    s_bfe_u32 s74, s47, 0x40014
    s_mul_i32 s74, s74, 5120
    s_add_u32 s74, s74, s72
    s_add_u32 s74, s74, s49
    s_add_u32 m0, s64, 15360
    s_nop 0
    buffer_load_dwordx4 v2, s[40:43], s74 offen offset:0 sc1 lds
    buffer_load_dwordx4 v2, s[40:43], s74 offen offset:1024 sc1 lds
    buffer_load_dwordx4 v2, s[40:43], s74 offen offset:2048 sc1 lds
    buffer_load_dwordx4 v2, s[40:43], s74 offen offset:3072 sc1 lds
    s_add_u32 m0, s64, 19456
    s_nop 0
    buffer_load_dwordx4 v3, s[40:43], s74 offen sc1 lds
    s_bfe_u32 s74, s46, 0x40008
    s_mul_i32 s74, s74, 5120
    s_add_u32 s74, s74, s72
    buffer_load_dwordx4 v[156:159], v2, s[40:43], s74 offen offset:0 sc1
    buffer_load_dwordx4 v[160:163], v2, s[40:43], s74 offen offset:1024 sc1
    buffer_load_dwordx4 v[164:167], v2, s[40:43], s74 offen offset:2048 sc1
    buffer_load_dwordx4 v[168:171], v2, s[40:43], s74 offen offset:3072 sc1
    buffer_load_dwordx4 v[172:175], v3, s[40:43], s74 offen sc1
    s_bfe_u32 s74, s46, 0x4000c
    s_mul_i32 s74, s74, 5120
    s_add_u32 s74, s74, s72
    buffer_load_dwordx4 v[176:179], v2, s[40:43], s74 offen offset:0 sc1
    buffer_load_dwordx4 v[180:183], v2, s[40:43], s74 offen offset:1024 sc1
    buffer_load_dwordx4 v[184:187], v2, s[40:43], s74 offen offset:2048 sc1
    buffer_load_dwordx4 v[188:191], v2, s[40:43], s74 offen offset:3072 sc1
    buffer_load_dwordx4 v[192:195], v3, s[40:43], s74 offen sc1
    s_bfe_u32 s74, s46, 0x40010
    s_mul_i32 s74, s74, 5120
    s_add_u32 s74, s74, s72
    buffer_load_dwordx4 v[196:199], v2, s[40:43], s74 offen offset:0 sc1
    buffer_load_dwordx4 v[200:203], v2, s[40:43], s74 offen offset:1024 sc1
    buffer_load_dwordx4 v[204:207], v2, s[40:43], s74 offen offset:2048 sc1
    buffer_load_dwordx4 v[208:211], v2, s[40:43], s74 offen offset:3072 sc1
    buffer_load_dwordx4 v[212:215], v3, s[40:43], s74 offen sc1
    buffer_load_dword v105, v104, s[40:43], s63 offen sc1
    s_bfe_u32 s74, s46, 0x40014
    s_mul_i32 s74, s74, 5120
    s_add_u32 s74, s74, s72
    buffer_load_dwordx4 v[216:219], v2, s[40:43], s74 offen offset:0 sc1
    buffer_load_dwordx4 v[220:223], v2, s[40:43], s74 offen offset:1024 sc1
    buffer_load_dwordx4 v[224:227], v2, s[40:43], s74 offen offset:2048 sc1
    buffer_load_dwordx4 v[228:231], v2, s[40:43], s74 offen offset:3072 sc1
    buffer_load_dwordx4 v[232:235], v3, s[40:43], s74 offen sc1
    s_bfe_u32 s74, s46, 0x40018
    s_mul_i32 s74, s74, 5120
    s_add_u32 s74, s74, s72
    buffer_load_dwordx4 v[236:239], v2, s[40:43], s74 offen offset:0 sc1
    buffer_load_dwordx4 v[240:243], v2, s[40:43], s74 offen offset:1024 sc1
    buffer_load_dwordx4 v[244:247], v2, s[40:43], s74 offen offset:2048 sc1
    buffer_load_dwordx4 v[248:251], v2, s[40:43], s74 offen offset:3072 sc1
    buffer_load_dwordx4 v[252:255], v3, s[40:43], s74 offen sc1
    s_waitcnt vmcnt(10)
    v_cmp_eq_u32 vcc, s59, v105
    s_nop 0
    s_cmp_eq_u64 vcc, -1
    s_cbranch_scc1 L_g_hok
    s_mov_b32 s77, 0
L_gp35:
    buffer_load_dword v105, v104, s[40:43], s63 offen sc1
    s_waitcnt vmcnt(0)
    v_cmp_eq_u32 vcc, s59, v105
    s_nop 0
    s_cmp_eq_u64 vcc, -1
    s_cbranch_scc1 L_gx35
    s_add_u32 s77, s77, 1
    s_cmp_ge_u32 s77, 20000
    s_cbranch_scc1 L_gx35
    s_sleep 3
    s_branch L_gp35
L_gx35:
L_g_hok:
    s_mul_i32 s64, s3, 20480
    s_add_u32 s64, s64, 256
    v_add_u32 v0, s64, v2
    s_bfe_u32 s50, s46, 0x40000
    s_mul_i32 s50, s50, 4096
    s_add_u32 s50, s50, s66
    buffer_load_dwordx4 v[84:87], v2, s[40:43], s50 offen offset:0 sc1
    buffer_load_dwordx4 v[88:91], v2, s[40:43], s50 offen offset:1024 sc1
    buffer_load_dwordx4 v[92:95], v2, s[40:43], s50 offen offset:2048 sc1
    buffer_load_dwordx4 v[96:99], v2, s[40:43], s50 offen offset:3072 sc1
    s_bfe_u32 s51, s46, 0x40004
    s_mul_i32 s51, s51, 4096
    s_add_u32 s51, s51, s66
    buffer_load_dwordx4 v[100:103], v2, s[40:43], s51 offen offset:0 sc1
    buffer_load_dwordx4 v[104:107], v2, s[40:43], s51 offen offset:1024 sc1
    buffer_load_dwordx4 v[108:111], v2, s[40:43], s51 offen offset:2048 sc1
    buffer_load_dwordx4 v[112:115], v2, s[40:43], s51 offen offset:3072 sc1
    s_waitcnt vmcnt(7)
    v_mfma_f32_16x16x32_bf16 v[4:7], v[116:119], v[84:87], 0
    v_mfma_f32_16x16x32_bf16 v[20:23], v[120:123], v[84:87], 0
    v_mfma_f32_16x16x32_bf16 v[36:39], v[124:127], v[84:87], 0
    v_mfma_f32_16x16x32_bf16 v[52:55], v[128:131], v[84:87], 0
    v_mfma_f32_16x16x32_bf16 v[68:71], v[132:135], v[84:87], 0
    s_bfe_u32 s50, s46, 0x40008
    s_mul_i32 s50, s50, 4096
    s_add_u32 s50, s50, s66
    buffer_load_dwordx4 v[84:87], v2, s[40:43], s50 offen offset:0 sc1
    s_waitcnt vmcnt(7)
    v_mfma_f32_16x16x32_bf16 v[72:75], v[132:135], v[88:91], 0
    v_mfma_f32_16x16x32_bf16 v[56:59], v[128:131], v[88:91], 0
    v_mfma_f32_16x16x32_bf16 v[40:43], v[124:127], v[88:91], 0
    v_mfma_f32_16x16x32_bf16 v[24:27], v[120:123], v[88:91], 0
    v_mfma_f32_16x16x32_bf16 v[8:11], v[116:119], v[88:91], 0
    buffer_load_dwordx4 v[88:91], v2, s[40:43], s50 offen offset:1024 sc1
    s_waitcnt vmcnt(7)
    v_mfma_f32_16x16x32_bf16 v[12:15], v[116:119], v[92:95], 0
    v_mfma_f32_16x16x32_bf16 v[28:31], v[120:123], v[92:95], 0
    v_mfma_f32_16x16x32_bf16 v[44:47], v[124:127], v[92:95], 0
    v_mfma_f32_16x16x32_bf16 v[60:63], v[128:131], v[92:95], 0
    v_mfma_f32_16x16x32_bf16 v[76:79], v[132:135], v[92:95], 0
    buffer_load_dwordx4 v[92:95], v2, s[40:43], s50 offen offset:2048 sc1
    s_waitcnt vmcnt(7)
    v_mfma_f32_16x16x32_bf16 v[80:83], v[132:135], v[96:99], 0
    v_mfma_f32_16x16x32_bf16 v[64:67], v[128:131], v[96:99], 0
    buffer_load_dwordx4 v[132:135], v2, s[40:43], s50 offen offset:3072 sc1
    v_mfma_f32_16x16x32_bf16 v[48:51], v[124:127], v[96:99], 0
    v_mfma_f32_16x16x32_bf16 v[32:35], v[120:123], v[96:99], 0
    s_bfe_u32 s51, s46, 0x4000c
    s_mul_i32 s51, s51, 4096
    s_add_u32 s51, s51, s66
    buffer_load_dwordx4 v[128:131], v2, s[40:43], s51 offen offset:0 sc1
    v_mfma_f32_16x16x32_bf16 v[16:19], v[116:119], v[96:99], 0
    buffer_load_dwordx4 v[124:127], v2, s[40:43], s51 offen offset:1024 sc1
    s_waitcnt vmcnt(9)
    v_mfma_f32_16x16x32_bf16 v[4:7], v[136:139], v[100:103], v[4:7]
    v_mfma_f32_16x16x32_bf16 v[20:23], v[140:143], v[100:103], v[20:23]
    buffer_load_dwordx4 v[120:123], v2, s[40:43], s51 offen offset:2048 sc1
    v_mfma_f32_16x16x32_bf16 v[36:39], v[144:147], v[100:103], v[36:39]
    v_mfma_f32_16x16x32_bf16 v[52:55], v[148:151], v[100:103], v[52:55]
    buffer_load_dwordx4 v[116:119], v2, s[40:43], s51 offen offset:3072 sc1
    v_mfma_f32_16x16x32_bf16 v[68:71], v[152:155], v[100:103], v[68:71]
    s_bfe_u32 s50, s46, 0x40010
    s_mul_i32 s50, s50, 4096
    s_add_u32 s50, s50, s66
    buffer_load_dwordx4 v[96:99], v2, s[40:43], s50 offen offset:0 sc1
    s_waitcnt vmcnt(11)
    v_mfma_f32_16x16x32_bf16 v[72:75], v[152:155], v[104:107], v[72:75]
    v_mfma_f32_16x16x32_bf16 v[56:59], v[148:151], v[104:107], v[56:59]
    buffer_load_dwordx4 v[100:103], v2, s[40:43], s50 offen offset:1024 sc1
    v_mfma_f32_16x16x32_bf16 v[40:43], v[144:147], v[104:107], v[40:43]
    v_mfma_f32_16x16x32_bf16 v[24:27], v[140:143], v[104:107], v[24:27]
    v_mfma_f32_16x16x32_bf16 v[8:11], v[136:139], v[104:107], v[8:11]
    buffer_load_dwordx4 v[104:107], v2, s[40:43], s50 offen offset:2048 sc1
    s_waitcnt vmcnt(12)
    v_mfma_f32_16x16x32_bf16 v[12:15], v[136:139], v[108:111], v[12:15]
    v_mfma_f32_16x16x32_bf16 v[28:31], v[140:143], v[108:111], v[28:31]
    v_mfma_f32_16x16x32_bf16 v[44:47], v[144:147], v[108:111], v[44:47]
    v_mfma_f32_16x16x32_bf16 v[60:63], v[148:151], v[108:111], v[60:63]
    v_mfma_f32_16x16x32_bf16 v[76:79], v[152:155], v[108:111], v[76:79]
    buffer_load_dwordx4 v[108:111], v2, s[40:43], s50 offen offset:3072 sc1
    s_waitcnt vmcnt(12)
    v_mfma_f32_16x16x32_bf16 v[80:83], v[152:155], v[112:115], v[80:83]
    v_mfma_f32_16x16x32_bf16 v[64:67], v[148:151], v[112:115], v[64:67]
    s_bfe_u32 s51, s46, 0x40014
    s_mul_i32 s51, s51, 4096
    s_add_u32 s51, s51, s66
    buffer_load_dwordx4 v[152:155], v2, s[40:43], s51 offen offset:0 sc1
    v_mfma_f32_16x16x32_bf16 v[48:51], v[144:147], v[112:115], v[48:51]
    v_mfma_f32_16x16x32_bf16 v[32:35], v[140:143], v[112:115], v[32:35]
    buffer_load_dwordx4 v[148:151], v2, s[40:43], s51 offen offset:1024 sc1
    v_mfma_f32_16x16x32_bf16 v[16:19], v[136:139], v[112:115], v[16:19]
    buffer_load_dwordx4 v[144:147], v2, s[40:43], s51 offen offset:2048 sc1
    s_waitcnt vmcnt(14)
    v_mfma_f32_16x16x32_bf16 v[4:7], v[156:159], v[84:87], v[4:7]
    v_mfma_f32_16x16x32_bf16 v[20:23], v[160:163], v[84:87], v[20:23]
    buffer_load_dwordx4 v[140:143], v2, s[40:43], s51 offen offset:3072 sc1
    v_mfma_f32_16x16x32_bf16 v[36:39], v[164:167], v[84:87], v[36:39]
    v_mfma_f32_16x16x32_bf16 v[52:55], v[168:171], v[84:87], v[52:55]
    s_bfe_u32 s50, s46, 0x40018
    s_mul_i32 s50, s50, 4096
    s_add_u32 s50, s50, s66
    buffer_load_dwordx4 v[136:139], v2, s[40:43], s50 offen offset:0 sc1
    v_mfma_f32_16x16x32_bf16 v[68:71], v[172:175], v[84:87], v[68:71]
    buffer_load_dwordx4 v[112:115], v2, s[40:43], s50 offen offset:1024 sc1
    s_waitcnt vmcnt(16)
    v_mfma_f32_16x16x32_bf16 v[72:75], v[172:175], v[88:91], v[72:75]
    v_mfma_f32_16x16x32_bf16 v[56:59], v[168:171], v[88:91], v[56:59]
    buffer_load_dwordx4 v[84:87], v2, s[40:43], s50 offen offset:2048 sc1
    v_mfma_f32_16x16x32_bf16 v[40:43], v[164:167], v[88:91], v[40:43]
    v_mfma_f32_16x16x32_bf16 v[24:27], v[160:163], v[88:91], v[24:27]
    v_mfma_f32_16x16x32_bf16 v[8:11], v[156:159], v[88:91], v[8:11]
    buffer_load_dwordx4 v[88:91], v2, s[40:43], s50 offen offset:3072 sc1
    s_waitcnt vmcnt(17)
    v_mfma_f32_16x16x32_bf16 v[12:15], v[156:159], v[92:95], v[12:15]
    v_mfma_f32_16x16x32_bf16 v[28:31], v[160:163], v[92:95], v[28:31]
    v_mfma_f32_16x16x32_bf16 v[44:47], v[164:167], v[92:95], v[44:47]
    v_mfma_f32_16x16x32_bf16 v[60:63], v[168:171], v[92:95], v[60:63]
    v_mfma_f32_16x16x32_bf16 v[76:79], v[172:175], v[92:95], v[76:79]
    s_bfe_u32 s74, s46, 0x4001c
    s_mul_i32 s74, s74, 5120
    s_add_u32 s74, s74, s72
    buffer_load_dwordx4 v[92:95], v2, s[40:43], s74 offen offset:0 sc1
    s_waitcnt vmcnt(17)
    v_mfma_f32_16x16x32_bf16 v[80:83], v[172:175], v[132:135], v[80:83]
    v_mfma_f32_16x16x32_bf16 v[64:67], v[168:171], v[132:135], v[64:67]
    buffer_load_dwordx4 v[172:175], v2, s[40:43], s74 offen offset:1024 sc1
    v_mfma_f32_16x16x32_bf16 v[48:51], v[164:167], v[132:135], v[48:51]
    v_mfma_f32_16x16x32_bf16 v[32:35], v[160:163], v[132:135], v[32:35]
    buffer_load_dwordx4 v[168:171], v2, s[40:43], s74 offen offset:2048 sc1
    v_mfma_f32_16x16x32_bf16 v[16:19], v[156:159], v[132:135], v[16:19]
    buffer_load_dwordx4 v[164:167], v2, s[40:43], s74 offen offset:3072 sc1
    s_waitcnt vmcnt(19)
    v_mfma_f32_16x16x32_bf16 v[4:7], v[176:179], v[128:131], v[4:7]
    v_mfma_f32_16x16x32_bf16 v[20:23], v[180:183], v[128:131], v[20:23]
    buffer_load_dwordx4 v[160:163], v3, s[40:43], s74 offen sc1
    v_mfma_f32_16x16x32_bf16 v[36:39], v[184:187], v[128:131], v[36:39]
    v_mfma_f32_16x16x32_bf16 v[52:55], v[188:191], v[128:131], v[52:55]
    s_bfe_u32 s51, s46, 0x4001c
    s_mul_i32 s51, s51, 4096
    s_add_u32 s51, s51, s66
    buffer_load_dwordx4 v[156:159], v2, s[40:43], s51 offen offset:0 sc1
    v_mfma_f32_16x16x32_bf16 v[68:71], v[192:195], v[128:131], v[68:71]
    buffer_load_dwordx4 v[132:135], v2, s[40:43], s51 offen offset:1024 sc1
    s_waitcnt vmcnt(21)
    v_mfma_f32_16x16x32_bf16 v[72:75], v[192:195], v[124:127], v[72:75]
    v_mfma_f32_16x16x32_bf16 v[56:59], v[188:191], v[124:127], v[56:59]
    buffer_load_dwordx4 v[128:131], v2, s[40:43], s51 offen offset:2048 sc1
    v_mfma_f32_16x16x32_bf16 v[40:43], v[184:187], v[124:127], v[40:43]
    v_mfma_f32_16x16x32_bf16 v[24:27], v[180:183], v[124:127], v[24:27]
    v_mfma_f32_16x16x32_bf16 v[8:11], v[176:179], v[124:127], v[8:11]
    buffer_load_dwordx4 v[124:127], v2, s[40:43], s51 offen offset:3072 sc1
    s_waitcnt vmcnt(22)
    v_mfma_f32_16x16x32_bf16 v[12:15], v[176:179], v[120:123], v[12:15]
    v_mfma_f32_16x16x32_bf16 v[28:31], v[180:183], v[120:123], v[28:31]
    v_mfma_f32_16x16x32_bf16 v[44:47], v[184:187], v[120:123], v[44:47]
    v_mfma_f32_16x16x32_bf16 v[60:63], v[188:191], v[120:123], v[60:63]
    v_mfma_f32_16x16x32_bf16 v[76:79], v[192:195], v[120:123], v[76:79]
    s_bfe_u32 s74, s47, 0x40000
    s_mul_i32 s74, s74, 5120
    s_add_u32 s74, s74, s72
    buffer_load_dwordx4 v[120:123], v2, s[40:43], s74 offen offset:0 sc1
    s_waitcnt vmcnt(22)
    v_mfma_f32_16x16x32_bf16 v[80:83], v[192:195], v[116:119], v[80:83]
    v_mfma_f32_16x16x32_bf16 v[64:67], v[188:191], v[116:119], v[64:67]
    buffer_load_dwordx4 v[192:195], v2, s[40:43], s74 offen offset:1024 sc1
    v_mfma_f32_16x16x32_bf16 v[48:51], v[184:187], v[116:119], v[48:51]
    v_mfma_f32_16x16x32_bf16 v[32:35], v[180:183], v[116:119], v[32:35]
    buffer_load_dwordx4 v[188:191], v2, s[40:43], s74 offen offset:2048 sc1
    v_mfma_f32_16x16x32_bf16 v[16:19], v[176:179], v[116:119], v[16:19]
    buffer_load_dwordx4 v[184:187], v2, s[40:43], s74 offen offset:3072 sc1
    s_waitcnt vmcnt(24)
    v_mfma_f32_16x16x32_bf16 v[4:7], v[196:199], v[96:99], v[4:7]
    v_mfma_f32_16x16x32_bf16 v[20:23], v[200:203], v[96:99], v[20:23]
    buffer_load_dwordx4 v[180:183], v3, s[40:43], s74 offen sc1
    v_mfma_f32_16x16x32_bf16 v[36:39], v[204:207], v[96:99], v[36:39]
    v_mfma_f32_16x16x32_bf16 v[52:55], v[208:211], v[96:99], v[52:55]
    s_bfe_u32 s50, s47, 0x40000
    s_mul_i32 s50, s50, 4096
    s_add_u32 s50, s50, s66
    buffer_load_dwordx4 v[176:179], v2, s[40:43], s50 offen offset:0 sc1
    v_mfma_f32_16x16x32_bf16 v[68:71], v[212:215], v[96:99], v[68:71]
    s_waitcnt vmcnt(25)
    v_mfma_f32_16x16x32_bf16 v[72:75], v[212:215], v[100:103], v[72:75]
    v_mfma_f32_16x16x32_bf16 v[56:59], v[208:211], v[100:103], v[56:59]
    buffer_load_dwordx4 v[116:119], v2, s[40:43], s50 offen offset:1024 sc1
    v_mfma_f32_16x16x32_bf16 v[40:43], v[204:207], v[100:103], v[40:43]
    v_mfma_f32_16x16x32_bf16 v[24:27], v[200:203], v[100:103], v[24:27]
    v_mfma_f32_16x16x32_bf16 v[8:11], v[196:199], v[100:103], v[8:11]
    s_waitcnt vmcnt(25)
    v_mfma_f32_16x16x32_bf16 v[12:15], v[196:199], v[104:107], v[12:15]
    v_mfma_f32_16x16x32_bf16 v[28:31], v[200:203], v[104:107], v[28:31]
    buffer_load_dwordx4 v[96:99], v2, s[40:43], s50 offen offset:2048 sc1
    v_mfma_f32_16x16x32_bf16 v[44:47], v[204:207], v[104:107], v[44:47]
    v_mfma_f32_16x16x32_bf16 v[60:63], v[208:211], v[104:107], v[60:63]
    v_mfma_f32_16x16x32_bf16 v[76:79], v[212:215], v[104:107], v[76:79]
    s_waitcnt vmcnt(25)
    v_mfma_f32_16x16x32_bf16 v[80:83], v[212:215], v[108:111], v[80:83]
    v_mfma_f32_16x16x32_bf16 v[64:67], v[208:211], v[108:111], v[64:67]
    buffer_load_dwordx4 v[100:103], v2, s[40:43], s50 offen offset:3072 sc1
    v_mfma_f32_16x16x32_bf16 v[48:51], v[204:207], v[108:111], v[48:51]
    v_mfma_f32_16x16x32_bf16 v[32:35], v[200:203], v[108:111], v[32:35]
    v_mfma_f32_16x16x32_bf16 v[16:19], v[196:199], v[108:111], v[16:19]
    s_waitcnt vmcnt(25)
    v_mfma_f32_16x16x32_bf16 v[4:7], v[216:219], v[152:155], v[4:7]
    v_mfma_f32_16x16x32_bf16 v[20:23], v[220:223], v[152:155], v[20:23]
    s_bfe_u32 s74, s47, 0x40004
    s_mul_i32 s74, s74, 5120
    s_add_u32 s74, s74, s72
    buffer_load_dwordx4 v[104:107], v2, s[40:43], s74 offen offset:0 sc1
    v_mfma_f32_16x16x32_bf16 v[36:39], v[224:227], v[152:155], v[36:39]
    v_mfma_f32_16x16x32_bf16 v[52:55], v[228:231], v[152:155], v[52:55]
    v_mfma_f32_16x16x32_bf16 v[68:71], v[232:235], v[152:155], v[68:71]
    s_waitcnt vmcnt(25)
    v_mfma_f32_16x16x32_bf16 v[72:75], v[232:235], v[148:151], v[72:75]
    v_mfma_f32_16x16x32_bf16 v[56:59], v[228:231], v[148:151], v[56:59]
    buffer_load_dwordx4 v[212:215], v2, s[40:43], s74 offen offset:1024 sc1
    v_mfma_f32_16x16x32_bf16 v[40:43], v[224:227], v[148:151], v[40:43]
    v_mfma_f32_16x16x32_bf16 v[24:27], v[220:223], v[148:151], v[24:27]
    v_mfma_f32_16x16x32_bf16 v[8:11], v[216:219], v[148:151], v[8:11]
    s_waitcnt vmcnt(25)
    v_mfma_f32_16x16x32_bf16 v[12:15], v[216:219], v[144:147], v[12:15]
    v_mfma_f32_16x16x32_bf16 v[28:31], v[220:223], v[144:147], v[28:31]
    buffer_load_dwordx4 v[208:211], v2, s[40:43], s74 offen offset:2048 sc1
    v_mfma_f32_16x16x32_bf16 v[44:47], v[224:227], v[144:147], v[44:47]
    v_mfma_f32_16x16x32_bf16 v[60:63], v[228:231], v[144:147], v[60:63]
    v_mfma_f32_16x16x32_bf16 v[76:79], v[232:235], v[144:147], v[76:79]
    s_waitcnt vmcnt(25)
    v_mfma_f32_16x16x32_bf16 v[80:83], v[232:235], v[140:143], v[80:83]
    v_mfma_f32_16x16x32_bf16 v[64:67], v[228:231], v[140:143], v[64:67]
    buffer_load_dwordx4 v[204:207], v2, s[40:43], s74 offen offset:3072 sc1
    v_mfma_f32_16x16x32_bf16 v[48:51], v[224:227], v[140:143], v[48:51]
    v_mfma_f32_16x16x32_bf16 v[32:35], v[220:223], v[140:143], v[32:35]
    v_mfma_f32_16x16x32_bf16 v[16:19], v[216:219], v[140:143], v[16:19]
    v_mov_b32 v140, s75
    v_mov_b32 v141, 13
    s_mov_b64 exec, 1
    ds_write_b32 v140, v141
    s_mov_b64 exec, -1
    s_waitcnt vmcnt(25)
    v_mfma_f32_16x16x32_bf16 v[4:7], v[236:239], v[136:139], v[4:7]
    v_mfma_f32_16x16x32_bf16 v[20:23], v[240:243], v[136:139], v[20:23]
    buffer_load_dwordx4 v[200:203], v3, s[40:43], s74 offen sc1
    v_mfma_f32_16x16x32_bf16 v[36:39], v[244:247], v[136:139], v[36:39]
    v_mfma_f32_16x16x32_bf16 v[52:55], v[248:251], v[136:139], v[52:55]
    v_mfma_f32_16x16x32_bf16 v[68:71], v[252:255], v[136:139], v[68:71]
    s_waitcnt vmcnt(25)
    v_mfma_f32_16x16x32_bf16 v[72:75], v[252:255], v[112:115], v[72:75]
    v_mfma_f32_16x16x32_bf16 v[56:59], v[248:251], v[112:115], v[56:59]
    s_bfe_u32 s51, s47, 0x40004
    s_mul_i32 s51, s51, 4096
    s_add_u32 s51, s51, s66
    buffer_load_dwordx4 v[196:199], v2, s[40:43], s51 offen offset:0 sc1
    v_mfma_f32_16x16x32_bf16 v[40:43], v[244:247], v[112:115], v[40:43]
    v_mfma_f32_16x16x32_bf16 v[24:27], v[240:243], v[112:115], v[24:27]
    v_mfma_f32_16x16x32_bf16 v[8:11], v[236:239], v[112:115], v[8:11]
    s_waitcnt vmcnt(25)
    v_mfma_f32_16x16x32_bf16 v[12:15], v[236:239], v[84:87], v[12:15]
    v_mfma_f32_16x16x32_bf16 v[28:31], v[240:243], v[84:87], v[28:31]
    buffer_load_dwordx4 v[108:111], v2, s[40:43], s51 offen offset:1024 sc1
    v_mfma_f32_16x16x32_bf16 v[44:47], v[244:247], v[84:87], v[44:47]
    v_mfma_f32_16x16x32_bf16 v[60:63], v[248:251], v[84:87], v[60:63]
    v_mfma_f32_16x16x32_bf16 v[76:79], v[252:255], v[84:87], v[76:79]
    s_waitcnt vmcnt(25)
    v_mfma_f32_16x16x32_bf16 v[80:83], v[252:255], v[88:91], v[80:83]
    v_mfma_f32_16x16x32_bf16 v[64:67], v[248:251], v[88:91], v[64:67]
    buffer_load_dwordx4 v[152:155], v2, s[40:43], s51 offen offset:2048 sc1
    v_mfma_f32_16x16x32_bf16 v[48:51], v[244:247], v[88:91], v[48:51]
    v_mfma_f32_16x16x32_bf16 v[32:35], v[240:243], v[88:91], v[32:35]
    v_mfma_f32_16x16x32_bf16 v[16:19], v[236:239], v[88:91], v[16:19]
    s_waitcnt vmcnt(20)
    v_mfma_f32_16x16x32_bf16 v[4:7], v[92:95], v[156:159], v[4:7]
    v_mfma_f32_16x16x32_bf16 v[20:23], v[172:175], v[156:159], v[20:23]
    buffer_load_dwordx4 v[148:151], v2, s[40:43], s51 offen offset:3072 sc1
    v_mfma_f32_16x16x32_bf16 v[36:39], v[168:171], v[156:159], v[36:39]
    v_mfma_f32_16x16x32_bf16 v[52:55], v[164:167], v[156:159], v[52:55]
    ds_read_b128 v[144:147], v0 offset:0
    v_mfma_f32_16x16x32_bf16 v[68:71], v[160:163], v[156:159], v[68:71]
    ds_read_b128 v[232:235], v0 offset:1024
    s_waitcnt vmcnt(20)
    v_mfma_f32_16x16x32_bf16 v[72:75], v[160:163], v[132:135], v[72:75]
    v_mfma_f32_16x16x32_bf16 v[56:59], v[164:167], v[132:135], v[56:59]
    ds_read_b128 v[228:231], v0 offset:2048
    v_mfma_f32_16x16x32_bf16 v[40:43], v[168:171], v[132:135], v[40:43]
    v_mfma_f32_16x16x32_bf16 v[24:27], v[172:175], v[132:135], v[24:27]
    ds_read_b128 v[224:227], v0 offset:3072
    v_mfma_f32_16x16x32_bf16 v[8:11], v[92:95], v[132:135], v[8:11]
    ds_read_b128 v[220:223], v0 offset:4096
    s_waitcnt vmcnt(19)
    v_mfma_f32_16x16x32_bf16 v[12:15], v[92:95], v[128:131], v[12:15]
    v_mfma_f32_16x16x32_bf16 v[28:31], v[172:175], v[128:131], v[28:31]
    s_bfe_u32 s50, s47, 0x40008
    s_mul_i32 s50, s50, 4096
    s_add_u32 s50, s50, s66
    buffer_load_dwordx4 v[216:219], v2, s[40:43], s50 offen offset:0 sc1
    v_mfma_f32_16x16x32_bf16 v[44:47], v[168:171], v[128:131], v[44:47]
    v_mfma_f32_16x16x32_bf16 v[60:63], v[164:167], v[128:131], v[60:63]
    buffer_load_dwordx4 v[140:143], v2, s[40:43], s50 offen offset:1024 sc1
    v_mfma_f32_16x16x32_bf16 v[76:79], v[160:163], v[128:131], v[76:79]
    buffer_load_dwordx4 v[136:139], v2, s[40:43], s50 offen offset:2048 sc1
    s_waitcnt vmcnt(21)
    v_mfma_f32_16x16x32_bf16 v[80:83], v[160:163], v[124:127], v[80:83]
    v_mfma_f32_16x16x32_bf16 v[64:67], v[164:167], v[124:127], v[64:67]
    buffer_load_dwordx4 v[112:115], v2, s[40:43], s50 offen offset:3072 sc1
    v_mfma_f32_16x16x32_bf16 v[48:51], v[168:171], v[124:127], v[48:51]
    v_mfma_f32_16x16x32_bf16 v[32:35], v[172:175], v[124:127], v[32:35]
    ds_read_b128 v[84:87], v0 offset:5120
    v_mfma_f32_16x16x32_bf16 v[16:19], v[92:95], v[124:127], v[16:19]
    ds_read_b128 v[252:255], v0 offset:6144
    s_waitcnt vmcnt(16)
    v_mfma_f32_16x16x32_bf16 v[4:7], v[120:123], v[176:179], v[4:7]
    v_mfma_f32_16x16x32_bf16 v[20:23], v[192:195], v[176:179], v[20:23]
    ds_read_b128 v[248:251], v0 offset:7168
    v_mfma_f32_16x16x32_bf16 v[36:39], v[188:191], v[176:179], v[36:39]
    v_mfma_f32_16x16x32_bf16 v[52:55], v[184:187], v[176:179], v[52:55]
    ds_read_b128 v[244:247], v0 offset:8192
    v_mfma_f32_16x16x32_bf16 v[68:71], v[180:183], v[176:179], v[68:71]
    ds_read_b128 v[240:243], v0 offset:9216
    s_waitcnt vmcnt(15)
    v_mfma_f32_16x16x32_bf16 v[72:75], v[180:183], v[116:119], v[72:75]
    v_mfma_f32_16x16x32_bf16 v[56:59], v[184:187], v[116:119], v[56:59]
    s_bfe_u32 s51, s47, 0x4000c
    s_mul_i32 s51, s51, 4096
    s_add_u32 s51, s51, s66
    buffer_load_dwordx4 v[236:239], v2, s[40:43], s51 offen offset:0 sc1
    v_mfma_f32_16x16x32_bf16 v[40:43], v[188:191], v[116:119], v[40:43]
    v_mfma_f32_16x16x32_bf16 v[24:27], v[192:195], v[116:119], v[24:27]
    buffer_load_dwordx4 v[88:91], v2, s[40:43], s51 offen offset:1024 sc1
    v_mfma_f32_16x16x32_bf16 v[8:11], v[120:123], v[116:119], v[8:11]
    buffer_load_dwordx4 v[156:159], v2, s[40:43], s51 offen offset:2048 sc1
    s_waitcnt vmcnt(17)
    v_mfma_f32_16x16x32_bf16 v[12:15], v[120:123], v[96:99], v[12:15]
    v_mfma_f32_16x16x32_bf16 v[28:31], v[192:195], v[96:99], v[28:31]
    buffer_load_dwordx4 v[132:135], v2, s[40:43], s51 offen offset:3072 sc1
    v_mfma_f32_16x16x32_bf16 v[44:47], v[188:191], v[96:99], v[44:47]
    v_mfma_f32_16x16x32_bf16 v[60:63], v[184:187], v[96:99], v[60:63]
    ds_read_b128 v[128:131], v0 offset:10240
    v_mfma_f32_16x16x32_bf16 v[76:79], v[180:183], v[96:99], v[76:79]
    ds_read_b128 v[160:163], v0 offset:11264
    s_waitcnt vmcnt(17)
    v_mfma_f32_16x16x32_bf16 v[80:83], v[180:183], v[100:103], v[80:83]
    v_mfma_f32_16x16x32_bf16 v[64:67], v[184:187], v[100:103], v[64:67]
    ds_read_b128 v[164:167], v0 offset:12288
    v_mfma_f32_16x16x32_bf16 v[48:51], v[188:191], v[100:103], v[48:51]
    v_mfma_f32_16x16x32_bf16 v[32:35], v[192:195], v[100:103], v[32:35]
    ds_read_b128 v[168:171], v0 offset:13312
    v_mfma_f32_16x16x32_bf16 v[16:19], v[120:123], v[100:103], v[16:19]
    ds_read_b128 v[172:175], v0 offset:14336
    s_waitcnt vmcnt(11)
    v_mfma_f32_16x16x32_bf16 v[4:7], v[104:107], v[196:199], v[4:7]
    v_mfma_f32_16x16x32_bf16 v[20:23], v[212:215], v[196:199], v[20:23]
    ds_read_b128 v[92:95], v0 offset:15360
    v_mfma_f32_16x16x32_bf16 v[36:39], v[208:211], v[196:199], v[36:39]
    v_mfma_f32_16x16x32_bf16 v[52:55], v[204:207], v[196:199], v[52:55]
    ds_read_b128 v[124:127], v0 offset:16384
    v_mfma_f32_16x16x32_bf16 v[68:71], v[200:203], v[196:199], v[68:71]
    ds_read_b128 v[176:179], v0 offset:17408
    s_waitcnt vmcnt(10)
    v_mfma_f32_16x16x32_bf16 v[72:75], v[200:203], v[108:111], v[72:75]
    v_mfma_f32_16x16x32_bf16 v[56:59], v[204:207], v[108:111], v[56:59]
    ds_read_b128 v[116:119], v0 offset:18432
    v_mfma_f32_16x16x32_bf16 v[40:43], v[208:211], v[108:111], v[40:43]
    v_mfma_f32_16x16x32_bf16 v[24:27], v[212:215], v[108:111], v[24:27]
    ds_read_b128 v[96:99], v0 offset:19456
    v_mfma_f32_16x16x32_bf16 v[8:11], v[104:107], v[108:111], v[8:11]
    s_bfe_u32 s50, s47, 0x40010
    s_mul_i32 s50, s50, 4096
    s_add_u32 s50, s50, s66
    s_add_u32 s50, s50, s49
    buffer_load_dwordx4 v[180:183], v2, s[40:43], s50 offen offset:0 sc1
    s_waitcnt vmcnt(10)
    v_mfma_f32_16x16x32_bf16 v[12:15], v[104:107], v[152:155], v[12:15]
    v_mfma_f32_16x16x32_bf16 v[28:31], v[212:215], v[152:155], v[28:31]
    s_bfe_u32 s51, s47, 0x40014
    s_mul_i32 s51, s51, 4096
    s_add_u32 s51, s51, s66
    s_add_u32 s51, s51, s49
    buffer_load_dwordx4 v[184:187], v2, s[40:43], s51 offen offset:0 sc1
    v_mfma_f32_16x16x32_bf16 v[44:47], v[208:211], v[152:155], v[44:47]
    v_mfma_f32_16x16x32_bf16 v[60:63], v[204:207], v[152:155], v[60:63]
    buffer_load_dwordx4 v[188:191], v2, s[40:43], s50 offen offset:1024 sc1
    v_mfma_f32_16x16x32_bf16 v[76:79], v[200:203], v[152:155], v[76:79]
    buffer_load_dwordx4 v[192:195], v2, s[40:43], s51 offen offset:1024 sc1
    s_waitcnt vmcnt(12)
    v_mfma_f32_16x16x32_bf16 v[80:83], v[200:203], v[148:151], v[80:83]
    v_mfma_f32_16x16x32_bf16 v[64:67], v[204:207], v[148:151], v[64:67]
    buffer_load_dwordx4 v[120:123], v2, s[40:43], s50 offen offset:2048 sc1
    v_mfma_f32_16x16x32_bf16 v[48:51], v[208:211], v[148:151], v[48:51]
    v_mfma_f32_16x16x32_bf16 v[32:35], v[212:215], v[148:151], v[32:35]
    buffer_load_dwordx4 v[100:103], v2, s[40:43], s51 offen offset:2048 sc1
    v_mfma_f32_16x16x32_bf16 v[16:19], v[104:107], v[148:151], v[16:19]
    buffer_load_dwordx4 v[196:199], v2, s[40:43], s50 offen offset:3072 sc1
    s_waitcnt vmcnt(14) lgkmcnt(15)
    v_mfma_f32_16x16x32_bf16 v[4:7], v[144:147], v[216:219], v[4:7]
    v_mfma_f32_16x16x32_bf16 v[20:23], v[232:235], v[216:219], v[20:23]
    buffer_load_dwordx4 v[108:111], v2, s[40:43], s51 offen offset:3072 sc1
    v_mfma_f32_16x16x32_bf16 v[36:39], v[228:231], v[216:219], v[36:39]
    v_mfma_f32_16x16x32_bf16 v[52:55], v[224:227], v[216:219], v[52:55]
    v_mfma_f32_16x16x32_bf16 v[68:71], v[220:223], v[216:219], v[68:71]
    s_waitcnt vmcnt(14)
    v_mfma_f32_16x16x32_bf16 v[72:75], v[220:223], v[140:143], v[72:75]
    v_mfma_f32_16x16x32_bf16 v[56:59], v[224:227], v[140:143], v[56:59]
    v_mfma_f32_16x16x32_bf16 v[40:43], v[228:231], v[140:143], v[40:43]
    v_mfma_f32_16x16x32_bf16 v[24:27], v[232:235], v[140:143], v[24:27]
    v_mfma_f32_16x16x32_bf16 v[8:11], v[144:147], v[140:143], v[8:11]
    s_waitcnt vmcnt(13)
    v_mfma_f32_16x16x32_bf16 v[12:15], v[144:147], v[136:139], v[12:15]
    v_mfma_f32_16x16x32_bf16 v[28:31], v[232:235], v[136:139], v[28:31]
    v_mfma_f32_16x16x32_bf16 v[44:47], v[228:231], v[136:139], v[44:47]
    v_mfma_f32_16x16x32_bf16 v[60:63], v[224:227], v[136:139], v[60:63]
    v_mfma_f32_16x16x32_bf16 v[76:79], v[220:223], v[136:139], v[76:79]
    s_waitcnt vmcnt(12)
    v_mfma_f32_16x16x32_bf16 v[80:83], v[220:223], v[112:115], v[80:83]
    v_mfma_f32_16x16x32_bf16 v[64:67], v[224:227], v[112:115], v[64:67]
    v_mfma_f32_16x16x32_bf16 v[48:51], v[228:231], v[112:115], v[48:51]
    v_mfma_f32_16x16x32_bf16 v[32:35], v[232:235], v[112:115], v[32:35]
    v_mfma_f32_16x16x32_bf16 v[16:19], v[144:147], v[112:115], v[16:19]
    s_waitcnt vmcnt(11) lgkmcnt(10)
    v_mfma_f32_16x16x32_bf16 v[4:7], v[84:87], v[236:239], v[4:7]
    v_mfma_f32_16x16x32_bf16 v[20:23], v[252:255], v[236:239], v[20:23]
    v_mfma_f32_16x16x32_bf16 v[36:39], v[248:251], v[236:239], v[36:39]
    v_mfma_f32_16x16x32_bf16 v[52:55], v[244:247], v[236:239], v[52:55]
    v_mfma_f32_16x16x32_bf16 v[68:71], v[240:243], v[236:239], v[68:71]
    s_waitcnt vmcnt(10)
    v_mfma_f32_16x16x32_bf16 v[72:75], v[240:243], v[88:91], v[72:75]
    v_mfma_f32_16x16x32_bf16 v[56:59], v[244:247], v[88:91], v[56:59]
    v_mfma_f32_16x16x32_bf16 v[40:43], v[248:251], v[88:91], v[40:43]
    v_mfma_f32_16x16x32_bf16 v[24:27], v[252:255], v[88:91], v[24:27]
    v_mfma_f32_16x16x32_bf16 v[8:11], v[84:87], v[88:91], v[8:11]
    s_waitcnt vmcnt(9)
    v_mfma_f32_16x16x32_bf16 v[12:15], v[84:87], v[156:159], v[12:15]
    v_mfma_f32_16x16x32_bf16 v[28:31], v[252:255], v[156:159], v[28:31]
    v_mfma_f32_16x16x32_bf16 v[44:47], v[248:251], v[156:159], v[44:47]
    v_mfma_f32_16x16x32_bf16 v[60:63], v[244:247], v[156:159], v[60:63]
    v_mfma_f32_16x16x32_bf16 v[76:79], v[240:243], v[156:159], v[76:79]
    s_waitcnt vmcnt(8)
    v_mfma_f32_16x16x32_bf16 v[80:83], v[240:243], v[132:135], v[80:83]
    v_mfma_f32_16x16x32_bf16 v[64:67], v[244:247], v[132:135], v[64:67]
    v_mfma_f32_16x16x32_bf16 v[48:51], v[248:251], v[132:135], v[48:51]
    v_mfma_f32_16x16x32_bf16 v[32:35], v[252:255], v[132:135], v[32:35]
    v_mfma_f32_16x16x32_bf16 v[16:19], v[84:87], v[132:135], v[16:19]
    v_lshrrev_b32 v152, 5, v1
    v_lshlrev_b32 v152, 6, v152
    v_xor_b32 v152, v152, v0
    v_xor_b32 v153, 128, v152
    v_lshrrev_b32 v154, 4, v1
    v_lshlrev_b32 v154, 6, v154
    v_xor_b32 v154, v154, v0
    s_cmp_eq_u32 s3, 3
    s_cbranch_scc1 L_g2_short
    s_waitcnt vmcnt(6) lgkmcnt(0)
    v_mfma_f32_16x16x32_bf16 v[4:7], v[128:131], v[180:183], v[4:7]
    v_mfma_f32_16x16x32_bf16 v[4:7], v[92:95], v[184:187], v[4:7]
    v_mfma_f32_16x16x32_bf16 v[20:23], v[124:127], v[184:187], v[20:23]
    v_mfma_f32_16x16x32_bf16 v[20:23], v[160:163], v[180:183], v[20:23]
    v_mfma_f32_16x16x32_bf16 v[36:39], v[164:167], v[180:183], v[36:39]
    v_mfma_f32_16x16x32_bf16 v[36:39], v[176:179], v[184:187], v[36:39]
    v_mfma_f32_16x16x32_bf16 v[52:55], v[116:119], v[184:187], v[52:55]
    v_mfma_f32_16x16x32_bf16 v[52:55], v[168:171], v[180:183], v[52:55]
    v_mfma_f32_16x16x32_bf16 v[68:71], v[172:175], v[180:183], v[68:71]
    v_mfma_f32_16x16x32_bf16 v[68:71], v[96:99], v[184:187], v[68:71]
    s_waitcnt vmcnt(4)
    v_mfma_f32_16x16x32_bf16 v[72:75], v[172:175], v[188:191], v[72:75]
    v_mfma_f32_16x16x32_bf16 v[72:75], v[96:99], v[192:195], v[72:75]
    ds_write_b128 v152, v[4:7] offset:0
    v_mfma_f32_16x16x32_bf16 v[56:59], v[116:119], v[192:195], v[56:59]
    v_mfma_f32_16x16x32_bf16 v[56:59], v[168:171], v[188:191], v[56:59]
    ds_write_b128 v153, v[20:23] offset:4096
    v_mfma_f32_16x16x32_bf16 v[40:43], v[164:167], v[188:191], v[40:43]
    v_mfma_f32_16x16x32_bf16 v[40:43], v[176:179], v[192:195], v[40:43]
    ds_write_b128 v152, v[36:39] offset:8192
    v_mfma_f32_16x16x32_bf16 v[24:27], v[124:127], v[192:195], v[24:27]
    v_mfma_f32_16x16x32_bf16 v[24:27], v[160:163], v[188:191], v[24:27]
    ds_write_b128 v153, v[52:55] offset:12288
    v_mfma_f32_16x16x32_bf16 v[8:11], v[128:131], v[188:191], v[8:11]
    v_mfma_f32_16x16x32_bf16 v[8:11], v[92:95], v[192:195], v[8:11]
    ds_write_b128 v154, v[68:71] offset:16384
    s_waitcnt vmcnt(2)
    v_mfma_f32_16x16x32_bf16 v[12:15], v[128:131], v[120:123], v[12:15]
    v_mfma_f32_16x16x32_bf16 v[12:15], v[92:95], v[100:103], v[12:15]
    ds_write_b128 v154, v[72:75] offset:17408
    v_mfma_f32_16x16x32_bf16 v[28:31], v[124:127], v[100:103], v[28:31]
    v_mfma_f32_16x16x32_bf16 v[28:31], v[160:163], v[120:123], v[28:31]
    ds_write_b128 v153, v[56:59] offset:13312
    v_mfma_f32_16x16x32_bf16 v[44:47], v[164:167], v[120:123], v[44:47]
    v_mfma_f32_16x16x32_bf16 v[44:47], v[176:179], v[100:103], v[44:47]
    ds_write_b128 v152, v[40:43] offset:9216
    v_mfma_f32_16x16x32_bf16 v[60:63], v[116:119], v[100:103], v[60:63]
    v_mfma_f32_16x16x32_bf16 v[60:63], v[168:171], v[120:123], v[60:63]
    ds_write_b128 v153, v[24:27] offset:5120
    v_mfma_f32_16x16x32_bf16 v[76:79], v[172:175], v[120:123], v[76:79]
    v_mfma_f32_16x16x32_bf16 v[76:79], v[96:99], v[100:103], v[76:79]
    ds_write_b128 v152, v[8:11] offset:1024
    s_waitcnt vmcnt(0)
    v_mfma_f32_16x16x32_bf16 v[80:83], v[172:175], v[196:199], v[80:83]
    v_mfma_f32_16x16x32_bf16 v[80:83], v[96:99], v[108:111], v[80:83]
    ds_write_b128 v152, v[12:15] offset:2048
    v_mfma_f32_16x16x32_bf16 v[64:67], v[116:119], v[108:111], v[64:67]
    v_mfma_f32_16x16x32_bf16 v[64:67], v[168:171], v[196:199], v[64:67]
    ds_write_b128 v153, v[28:31] offset:6144
    v_mfma_f32_16x16x32_bf16 v[48:51], v[164:167], v[196:199], v[48:51]
    v_mfma_f32_16x16x32_bf16 v[48:51], v[176:179], v[108:111], v[48:51]
    ds_write_b128 v152, v[44:47] offset:10240
    v_mfma_f32_16x16x32_bf16 v[32:35], v[124:127], v[108:111], v[32:35]
    v_mfma_f32_16x16x32_bf16 v[32:35], v[160:163], v[196:199], v[32:35]
    ds_write_b128 v153, v[60:63] offset:14336
    v_mfma_f32_16x16x32_bf16 v[16:19], v[128:131], v[196:199], v[16:19]
    v_mfma_f32_16x16x32_bf16 v[16:19], v[92:95], v[108:111], v[16:19]
    ds_write_b128 v154, v[76:79] offset:18432
    ds_write_b128 v154, v[80:83] offset:19456
    ds_write_b128 v153, v[64:67] offset:15360
    ds_write_b128 v152, v[48:51] offset:11264
    s_nop 0
    ds_write_b128 v153, v[32:35] offset:7168
    s_nop 1
    ds_write_b128 v152, v[16:19] offset:3072
L_g2_end:
    s_waitcnt lgkmcnt(0)
    s_barrier
    s_endpgm
L_g2_short:
    ds_write_b128 v152, v[4:7] offset:0
    ds_write_b128 v153, v[20:23] offset:4096
    ds_write_b128 v152, v[36:39] offset:8192
    ds_write_b128 v153, v[52:55] offset:12288
    ds_write_b128 v154, v[68:71] offset:16384
    ds_write_b128 v152, v[8:11] offset:1024
    ds_write_b128 v153, v[24:27] offset:5120
    ds_write_b128 v152, v[40:43] offset:9216
    ds_write_b128 v153, v[56:59] offset:13312
    ds_write_b128 v154, v[72:75] offset:17408
    ds_write_b128 v152, v[12:15] offset:2048
    ds_write_b128 v153, v[28:31] offset:6144
    ds_write_b128 v152, v[44:47] offset:10240
    ds_write_b128 v153, v[60:63] offset:14336
    ds_write_b128 v154, v[76:79] offset:18432
    ds_write_b128 v152, v[16:19] offset:3072
    ds_write_b128 v153, v[32:35] offset:7168
    ds_write_b128 v152, v[48:51] offset:11264
    ds_write_b128 v153, v[64:67] offset:15360
    ds_write_b128 v154, v[80:83] offset:19456
    s_branch L_g2_end
L_exit:
    s_endpgm
L_code_end:
.section .rodata,"a"
.p2align 6
.amdhsa_kernel recurrent_scan__ssm_conv_s4__dense_activation_gelu__prompt_kernel
  .amdhsa_next_free_vgpr 256
  .amdhsa_next_free_sgpr 102
  .amdhsa_accum_offset 256
  .amdhsa_group_segment_fixed_size 0
  .amdhsa_kernarg_size 136
  .amdhsa_user_sgpr_count 2
  .amdhsa_user_sgpr_kernarg_segment_ptr 1
  .amdhsa_system_sgpr_workgroup_id_x 1
.end_amdhsa_kernel
```
